```python
import torch

def _softmax(x, axis=-1):
    return torch.softmax(x, dim=axis)
def _gelu(x):
    return torch.nn.functional.gelu(x, approximate="tanh")
def _silu(x):
    return torch.nn.functional.silu(x)
def _sigmoid(x):
    return torch.sigmoid(x)
def _layernorm(x, axis=-1, eps=1e-5):
    m = x.mean(dim=axis, keepdim=True)
    v = x.var(dim=axis, keepdim=True, unbiased=False)
    return (x - m) / torch.sqrt(v + eps)
def _scatter_add(tgt, idx, src, axis=0):
    return tgt.clone().index_add_(axis, idx, src)
def _segment_sum(src, seg, n):
    out = torch.zeros((n,) + src.shape[1:], dtype=src.dtype)
    return out.index_add_(0, seg, src)
def _pad(x, pw):
    flat = tuple(v for pair in reversed(pw) for v in pair)
    return torch.nn.functional.pad(x, flat)

kernel_name = 'parallel_sum__sliding_local_dilated__mixer_s_mlp__prompt'

def setup_inputs():

    _w = (lambda a: (lambda t: t.to(torch.bfloat16) if t.is_floating_point() else t)(torch.as_tensor(a)))
    def _A_setup():
        B, S, D = 1, 2048, 512
        return {
            "x": _w((lambda *s: torch.randn(*s, dtype=torch.bfloat16) * 0.05)(B, S, D)),
            "wqkv": _w((lambda *s: torch.randn(*s, dtype=torch.bfloat16) * 0.05)(D, 3 * D)),
            "wo": _w((lambda *s: torch.randn(*s, dtype=torch.bfloat16) * 0.05)(D, D)),
        }
    _A_in = _A_setup()

    def _B_setup():
        B, S, D, F = 1, 2048, 512, 1792
        return {
            "x":  _w((lambda *s: torch.randn(*s, dtype=torch.bfloat16) * 0.05)(B, S, D)),
            "w1": _w((lambda *s: torch.randn(*s, dtype=torch.bfloat16) * 0.8)(D, D) * (D ** -0.5)),
            "w2": _w((lambda *s: torch.randn(*s, dtype=torch.bfloat16) * 0.8)(D, D) * (D ** -0.5)),
            "w3": _w((lambda *s: torch.randn(*s, dtype=torch.bfloat16) * 0.8)(D, F) * (D ** -0.5)),
            "w4": _w((lambda *s: torch.randn(*s, dtype=torch.bfloat16) * 0.8)(F, D) * (F ** -0.5)),
        }
    _B_in = _B_setup()

    return {
        "A_x": _A_in["x"],
        "A_wqkv": _A_in["wqkv"],
        "A_wo": _A_in["wo"],
        "B_x": _B_in["x"],
        "B_w1": _B_in["w1"],
        "B_w2": _B_in["w2"],
        "B_w3": _B_in["w3"],
        "B_w4": _B_in["w4"],
    }

def reference(A_x, A_wqkv, A_wo, B_x, B_w1, B_w2, B_w3, B_w4):
    def _A_ref(x, wqkv, wo):
        B, S, D = x.shape
        H = 32; Dh = D // H
        W, dil = 8, 2
        qkv = (lambda x, *d: x.permute(*d))((x @ wqkv).reshape(B, S, 3, H, Dh), 2, 0, 3, 1, 4)
        q, k, v = qkv[0], qkv[1], qkv[2]
        scale = Dh ** -0.5
        pos = torch.arange(S)
        off = torch.arange(W) * dil
        idx = pos[:, None] - off[None, :]
        mask = idx >= 0
        idx_c = torch.where(mask, idx, 0).reshape(-1)
        kg = k[:, :, idx_c, :].reshape(B, H, S, W, Dh)
        vg = v[:, :, idx_c, :].reshape(B, H, S, W, Dh)
        logits = torch.einsum("bhsd,bhswd->bhsw", q, kg) * scale
        logits = torch.where(mask[None, None, :, :], logits, -1e9)
        attn = _softmax(logits, axis=-1)
        o = torch.einsum("bhsw,bhswd->bhsd", attn, vg)
        return (lambda x, *d: x.permute(*d))(o, 0, 2, 1, 3).reshape(B, S, D) @ wo

    def _B_ref(x, w1, w2, w3, w4):
        B, S, D = x.shape
        h = _gelu(_layernorm(x, axis=-1) @ w1)
        c = D // 4
        g0 = _pad(h[:, :, 0*c:1*c], ((0, 0), (1, 0), (0, 0)))[:, :S, :]
        g1 = _pad(h[:, :, 1*c:2*c], ((0, 0), (0, 1), (0, 0)))[:, 1:, :]
        g2 = _pad(h[:, :, 2*c:3*c], ((0, 0), (2, 0), (0, 0)))[:, :S, :]
        g3 = _pad(h[:, :, 3*c:   ], ((0, 0), (0, 2), (0, 0)))[:, 2:, :]
        hs = torch.concatenate([g0, g1, g2, g3], axis=-1) @ w2
        x1 = x + hs
        h2 = _gelu(_layernorm(x1, axis=-1) @ w3) @ w4
        return x1 + h2

    x = A_x
    xn = _layernorm(x, axis=-1)
    return x + _A_ref(xn, A_wqkv, A_wo) + _B_ref(xn, B_w1, B_w2, B_w3, B_w4)
```

```asm
; @launch grid=(256,1,1) block=(256,1,1) lds=163840
.amdgcn_target "amdgcn-amd-amdhsa--gfx950"
.text
.globl parallel_sum__sliding_local_dilated__mixer_s_mlp__prompt_kernel
.p2align 8
.type parallel_sum__sliding_local_dilated__mixer_s_mlp__prompt_kernel,@function
parallel_sum__sliding_local_dilated__mixer_s_mlp__prompt_kernel:
    s_cmp_ge_u32 s2, 256
    s_cbranch_scc1 Lend
    s_load_dwordx2 s[4:5], s[0:1], 0
    s_load_dwordx2 s[16:17], s[0:1], 32
    s_load_dwordx2 s[8:9], s[0:1], 8
    s_load_dwordx2 s[36:37], s[0:1], 80
    s_load_dwordx2 s[40:41], s[0:1], 72
    s_load_dwordx2 s[20:21], s[0:1], 40
    s_load_dwordx2 s[24:25], s[0:1], 48
    s_load_dwordx2 s[28:29], s[0:1], 56
    s_load_dwordx2 s[12:13], s[0:1], 16
    s_load_dwordx2 s[32:33], s[0:1], 64
    s_getpc_b64 s[44:45]
Lpc:
    s_mov_b32 s46, Lend-Lpc
    s_mov_b32 s47, 0x20000
    v_and_b32 v1, 63, v0
    v_lshrrev_b32 v136, 6, v0
    s_nop 0
    v_readfirstlane_b32 s48, v136
    v_lshlrev_b32_e64 v12, 7, v1
    s_bfe_u32 s3, s2, 0x30003
    s_lshl_b32 s3, s3, 2
    s_add_u32 s3, s3, s48
    s_mul_i32 s3, s3, 1408
    s_bfm_b64 exec, 11, 0
    buffer_load_dword v13, v12, s[44:47], s3 offen
    s_mov_b64 exec, -1
    s_lshr_b32 s80, s2, 3
    s_and_b32 s81, s2, 6
    s_lshl_b32 s81, s81, 2
    s_lshr_b32 s82, s80, 2
    s_add_u32 s49, s81, s82
    s_and_b32 s81, s2, 1
    s_lshl_b32 s82, s81, 2
    s_and_b32 s50, s80, 3
    s_add_u32 s50, s50, s82
    s_lshl_b32 s82, s50, 1
    s_add_u32 s53, s49, s82
    s_add_u32 s53, s53, s81
    s_and_b32 s53, s53, 7
    s_lshl_b32 s54, s48, 10
    s_lshl_b32 s99, s48, 14
    s_nop 0
    s_mov_b32 s6, 2097152
    s_mov_b32 s7, 0x20000
    s_mov_b32 s18, 524288
    s_mov_b32 s19, 0x20000
    s_lshl_b32 s56, s53, 7
    s_lshl_b32 s64, s53, 16
    v_lshrrev_b32 v136, 3, v1
    v_and_b32 v137, 7, v1
    v_lshrrev_b32 v141, 4, v1
    v_xor_b32 v138, v141, v137
    v_lshlrev_b32_e64 v138, 4, v138
    v_lshl_add_u32 v138, v136, 11, v138
    s_lshr_b32 s81, s48, 1
    s_lshl_b32 s81, s81, 5
    s_and_b32 s82, s48, 1
    s_add_u32 s81, s81, s82
    s_lshl_b32 s83, s49, 6
    s_add_u32 s81, s81, s83
    s_lshl_b32 s81, s81, 10
    v_add_u32 v145, s81, v138
    v_xor_b32_e64 v146, 64, v145
    v_add_u32 v146, 16384, v146
    s_add_u32 s81, s83, s82
    s_sub_u32 s81, s81, 16
    s_lshl_b32 s81, s81, 10
    s_lshl_b32 s83, s82, 6
    v_xor_b32 v147, s83, v138
    v_add_u32 v147, s81, v147
    v_lshlrev_b32 v139, 1, v136
    v_and_b32 v139, 4, v139
    v_xor_b32 v139, v139, v137
    s_lshl_b32 s82, s82, 1
    v_xor_b32 v139, s82, v139
    v_lshlrev_b32 v139, 4, v139
    s_lshl_b32 s81, s48, 3
    v_add_u32 v138, s81, v136
    s_lshl_b32 s81, s50, 7
    v_add_u32 v136, s81, v139
    v_lshl_add_u32 v2, v138, 10, v136
    s_waitcnt lgkmcnt(0)
    s_add_u32 m0, s99, 0
    s_nop 0
    buffer_load_dwordx4 v145, s[4:7], s56 offen lds
    s_add_u32 m0, s99, 1024
    s_nop 0
    buffer_load_dwordx4 v146, s[4:7], s56 offen lds
    s_add_u32 m0, s54, 90112
    s_nop 0
    s_nop 0
    buffer_load_dwordx4 v2, s[16:19], s64 offen lds
    s_add_u32 m0, s54, 94208
    s_add_u32 s80, s64, 32768
    buffer_load_dwordx4 v2, s[16:19], s80 offen lds
    s_add_u32 s81, s53, 1
    s_and_b32 s81, s81, 7
    s_lshl_b32 s57, s81, 7
    s_lshl_b32 s65, s81, 16
    s_add_u32 m0, s99, 2048
    s_nop 0
    buffer_load_dwordx4 v145, s[4:7], s57 offen lds
    s_add_u32 m0, s99, 3072
    s_nop 0
    buffer_load_dwordx4 v146, s[4:7], s57 offen lds
    s_add_u32 m0, s54, 98304
    s_nop 0
    s_nop 0
    buffer_load_dwordx4 v2, s[16:19], s65 offen lds
    s_add_u32 m0, s54, 102400
    s_add_u32 s80, s65, 32768
    buffer_load_dwordx4 v2, s[16:19], s80 offen lds
    s_add_u32 s81, s53, 2
    s_and_b32 s81, s81, 7
    s_lshl_b32 s58, s81, 7
    s_lshl_b32 s66, s81, 16
    s_add_u32 s81, s53, 3
    s_and_b32 s81, s81, 7
    s_lshl_b32 s59, s81, 7
    s_lshl_b32 s67, s81, 16
    s_add_u32 s81, s53, 4
    s_and_b32 s81, s81, 7
    s_lshl_b32 s60, s81, 7
    s_lshl_b32 s68, s81, 16
    s_add_u32 s81, s53, 5
    s_and_b32 s81, s81, 7
    s_lshl_b32 s61, s81, 7
    s_lshl_b32 s69, s81, 16
    s_add_u32 s81, s53, 6
    s_and_b32 s81, s81, 7
    s_lshl_b32 s62, s81, 7
    s_lshl_b32 s70, s81, 16
    s_add_u32 s81, s53, 7
    s_and_b32 s81, s81, 7
    s_lshl_b32 s63, s81, 7
    s_lshl_b32 s71, s81, 16
    s_mov_b32 s10, 1572864
    s_mov_b32 s11, 0x20000
    s_mov_b32 s38, 20971520
    s_mov_b32 s39, 0x20000
    s_mov_b32 s42, 256
    s_mov_b32 s43, 0x20000
    s_mov_b32 s22, 524288
    s_mov_b32 s23, 0x20000
    s_mov_b32 s26, 1835008
    s_mov_b32 s27, 0x20000
    s_mov_b32 s30, 1835008
    s_mov_b32 s31, 0x20000
    s_mov_b32 s14, 524288
    s_mov_b32 s15, 0x20000
    s_mov_b32 s34, 2097152
    s_mov_b32 s35, 0x20000
    s_lshl_b32 s81, s2, 2
    s_add_u32 s81, s81, s48
    s_mul_i32 s82, s81, 1536
    s_bfm_b64 exec, 12, 0
    buffer_load_dword v13, v12, s[8:11], s82 offen
    s_mov_b64 exec, -1
    v_mul_u32_u24 v3, 3072, v138
    v_add_u32 v3, v3, v136
    s_lshr_b32 s51, s49, 1
    s_and_b32 s81, s2, 1
    s_mul_i32 s81, s81, 7
    s_bfe_u32 s82, s2, 0x30003
    s_add_u32 s52, s81, s82
    s_cmp_eq_u32 s82, 7
    s_cselect_b32 s52, 14, s52
    s_and_b32 s81, s52, 15
    s_lshl_b32 s81, s81, 8
    v_add_u32 v136, s81, v139
    v_mul_u32_u24 v4, 3584, v138
    v_add_u32_e64 v4, v4, v136
    v_subrev_u32 v136, 384, v2
    s_cmp_ge_u32 s52, 14
    s_cselect_b64 vcc, -1, 0
    s_nop 0
    v_cndmask_b32 v4, v4, v136, vcc
    s_mul_i32 s72, s64, 3
    s_mul_i32 s73, s65, 3
    s_mul_i32 s74, s66, 3
    s_mul_i32 s75, s67, 3
    s_mul_i32 s76, s68, 3
    s_mul_i32 s77, s69, 3
    s_mul_i32 s78, s70, 3
    s_mul_i32 s79, s71, 3
    v_mov_b32 v32, 0x3f803f80
    v_mov_b32 v33, 0x3f803f80
    v_mov_b32 v34, 0x3f803f80
    v_mov_b32 v35, 0x3f803f80
    v_lshrrev_b32 v136, 3, v1
    v_lshlrev_b32 v136, 11, v136
    v_lshl_add_u32 v136, v137, 4, v136
    v_add_u32 v136, 65536, v136
    ds_write_b128 v136, v[32:35]
    ds_write_b128 v136, v[32:35] offset:1024
    v_mov_b32 v42, 0
    v_mov_b32 v43, 1
    v_and_b32_e64 v140, 15, v1
    v_bfe_u32 v142, v1, 2, 2
    v_and_b32 v143, 3, v1
    v_lshrrev_b32 v136, 1, v140
    v_xor_b32 v136, v136, v141
    v_lshlrev_b32 v136, 4, v136
    v_lshl_add_u32 v8, v140, 7, v136
    v_xor_b32_e64 v9, 64, v8
    v_add_u32 v10, 65536, v8
    v_add_u32 v11, 65536, v9
    v_lshrrev_b32 v136, 1, v143
    s_lshl_b32 s81, s48, 1
    v_add_u32 v136, s81, v136
    v_lshlrev_b32 v137, 1, v142
    v_and_b32 v137, 4, v137
    v_and_b32 v138, 1, v141
    v_lshl_add_u32 v138, v138, 1, v137
    v_xor_b32_e64 v136, v136, v138
    v_lshl_add_u32 v138, v141, 3, v142
    v_lshlrev_b32_e64 v138, 7, v138
    v_lshl_add_u32 v136, v136, 4, v138
    v_and_b32_e64 v138, 1, v143
    v_lshl_add_u32 v136, v138, 3, v136
    v_add_u32 v5, 81920, v136
    v_add_u32 v6, 118784, v136
    s_xor_b32 s81, s48, 0
    s_lshl_b32 s81, s81, 14
    v_add_u32 v148, s81, v8
    v_add_u32 v149, s81, v9
    s_xor_b32 s81, s48, 1
    s_lshl_b32 s81, s81, 14
    v_add_u32 v150, s81, v8
    v_add_u32 v151, s81, v9
    s_xor_b32 s81, s48, 2
    s_lshl_b32 s81, s81, 14
    v_add_u32 v152, s81, v8
    v_add_u32 v153, s81, v9
    s_xor_b32 s81, s48, 3
    s_lshl_b32 s81, s81, 14
    v_add_u32 v154, s81, v8
    v_add_u32 v155, s81, v9
    v_mov_b32 v40, 0xc0135761
    v_mov_b32 v41, 0xc0135761
    s_mov_b32 s100, 0xbdd2d3e8
    s_mov_b32 s101, 0xbdd2d3e8
    s_mov_b32 s84, 0x22222222
    s_mov_b32 s85, 0x22222222
    s_mov_b32 s86, 0x44444444
    s_mov_b32 s87, 0x44444444
    s_mov_b32 s88, 0x88888888
    s_mov_b32 s89, 0x88888888
    s_mov_b32 s90, 0x00F0000F
    s_mov_b32 s91, 0xF0000F00
    v_lshlrev_b32_e64 v101, 2, v140
    v_add_u32 v101, 155648, v101
    s_xor_b32 s81, s48, 0
    s_lshl_b32 s81, s81, 6
    v_add_u32 v156, s81, v101
    s_xor_b32 s81, s48, 1
    s_lshl_b32 s81, s81, 6
    v_add_u32 v157, s81, v101
    s_xor_b32 s81, s48, 2
    s_lshl_b32 s81, s81, 6
    v_add_u32 v158, s81, v101
    s_xor_b32 s81, s48, 3
    s_lshl_b32 s81, s81, 6
    v_add_u32 v159, s81, v101
    s_lshr_b32 s83, s50, 2
    s_add_u32 s83, s83, 1
    s_sub_u32 s82, 0, s83
    s_bitcmp1_b32 s50, 1
    s_cselect_b32 s83, s82, s83
    v_bfe_u32 v136, v1, 4, 1
    v_add_u32 v136, 0, v136
    v_xor_b32 v136, s48, v136
    v_and_b32 v137, 1, v136
    v_lshrrev_b32_e64 v136, 1, v136
    v_lshl_add_u32 v136, v136, 5, v137
    v_lshl_add_u32 v136, v140, 1, v136
    s_lshl_b32 s81, s49, 6
    v_add_u32 v136, s81, v136
    v_lshrrev_b32 v137, 5, v136
    v_lshlrev_b32 v137, 15, v137
    v_add_u32 v136, s83, v136
    v_and_b32 v138, 1, v136
    v_lshl_add_u32 v137, v138, 8, v137
    v_bfe_u32 v138, v136, 1, 4
    v_lshl_add_u32 v137, v138, 4, v137
    v_lshrrev_b32_e64 v138, 5, v1
    v_lshl_add_u32 v137, v138, 9, v137
    s_lshl_b32 s81, s50, 2
    s_add_u32 s81, s81, s48
    s_lshl_b32 s81, s81, 10
    s_add_u32 s81, s81, 0
    v_add_u32_e64 v160, s81, v137
    v_bfe_u32 v136, v1, 4, 1
    v_add_u32 v136, 2, v136
    v_xor_b32 v136, s48, v136
    v_and_b32 v137, 1, v136
    v_lshrrev_b32 v136, 1, v136
    v_lshl_add_u32 v136, v136, 5, v137
    v_lshl_add_u32 v136, v140, 1, v136
    s_lshl_b32 s81, s49, 6
    v_add_u32 v136, s81, v136
    v_lshrrev_b32 v137, 5, v136
    v_lshlrev_b32 v137, 15, v137
    v_add_u32 v136, s83, v136
    v_and_b32 v138, 1, v136
    v_lshl_add_u32 v137, v138, 8, v137
    v_bfe_u32 v138, v136, 1, 4
    v_lshl_add_u32 v137, v138, 4, v137
    v_lshrrev_b32_e64 v138, 5, v1
    v_lshl_add_u32 v137, v138, 9, v137
    s_lshl_b32 s81, s50, 2
    s_add_u32 s81, s81, s48
    s_lshl_b32 s81, s81, 10
    s_add_u32 s81, s81, 0
    v_add_u32 v161, s81, v137
    v_lshrrev_b32 v137, 1, v140
    v_lshrrev_b32 v138, 5, v1
    v_lshlrev_b32 v138, 1, v138
    s_and_b32 s81, s48, 2
    s_lshl_b32 s81, s81, 1
    v_add_u32 v138, s81, v138
    v_xor_b32 v137, v137, v138
    v_lshlrev_b32_e64 v137, 4, v137
    v_lshl_add_u32 v137, v140, 7, v137
    v_bfe_u32 v138, v1, 4, 1
    v_lshl_add_u32 v137, v138, 14, v137
    s_sub_u32 s81, s50, s53
    s_and_b32 s81, s81, 7
    s_lshl_b32 s81, s81, 11
    s_and_b32 s82, s48, 1
    s_lshl_b32 s83, s82, 15
    s_add_u32 s81, s81, s83
    v_add_u32 v162, s81, v137
    v_xor_b32 v163, 16, v162
    v_and_b32 v136, 31, v1
    v_lshlrev_b32 v164, 2, v136
    s_lshl_b32 s82, s82, 7
    s_add_u32 s82, s82, 155648
    v_add_u32 v164, s82, v164
    s_cmp_ge_u32 s52, 14
    s_cselect_b32 s0, 1, s48
    s_mov_b32 s1, 1
    s_lshl_b32 s81, s49, 2
    s_add_u32 s81, s81, s48
    s_lshl_b32 s81, s81, 14
    s_lshl_b32 s82, s50, 7
    s_add_u32 s81, s81, s82
    v_lshrrev_b32 v136, 3, v1
    v_lshlrev_b32 v136, 11, v136
    v_and_b32_e64 v137, 7, v1
    v_lshl_add_u32 v136, v137, 4, v136
    v_add_u32_e64 v26, s81, v136
    v_xor_b32 v25, 65536, v26
    s_lshl_b32 s82, s49, 1
    s_and_b32 s81, s48, 1
    s_add_u32 s82, s82, s81
    s_lshr_b32 s81, s48, 1
    s_lshl_b32 s81, s81, 10
    v_lshl_add_u32 v136, v1, 4, s81
    s_and_b32 s81, s49, 1
    s_lshl_b32 s83, s81, 14
    v_add_u32 v137, s83, v136
    s_mul_i32 s83, s81, 28672
    s_add_u32 s83, s83, 6291456
    v_add_u32_e64 v138, s83, v136
    s_mul_i32 s81, s82, 57344
    v_add_u32 v23, s81, v138
    s_xor_b32 s83, s82, 2
    s_mul_i32 s81, s83, 57344
    v_add_u32 v22, s81, v138
    s_lshl_b32 s83, s83, 15
    v_add_u32 v20, s83, v137
    s_lshl_b32 s83, s82, 15
    v_add_u32_e64 v21, s83, v137
    v_bfe_u32 v137, v1, 4, 1
    v_lshl_add_u32 v137, v140, 1, v137
    s_lshl_b32 s81, s82, 5
    v_add_u32 v137, s81, v137
    v_add_u32 v138, -1, v137
    v_lshrrev_b32 v139, 11, v138
    v_min_u32 v139, 1, v139
    v_lshlrev_b32 v139, 31, v139
    v_bfe_u32 v138, v138, 5, 6
    v_lshl_add_u32 v138, v138, 15, v136
    v_or_b32 v14, v138, v139
    v_add_u32 v138, 1, v137
    v_lshrrev_b32 v139, 11, v138
    v_min_u32 v139, 1, v139
    v_lshlrev_b32_e64 v139, 31, v139
    v_bfe_u32 v138, v138, 5, 6
    v_lshl_add_u32 v138, v138, 15, v136
    v_or_b32 v15, v138, v139
    v_add_u32 v138, -2, v137
    v_lshrrev_b32 v139, 11, v138
    v_min_u32 v139, 1, v139
    v_lshlrev_b32_e64 v139, 31, v139
    v_bfe_u32 v138, v138, 5, 6
    v_lshl_add_u32 v138, v138, 15, v136
    v_or_b32 v16, v138, v139
    v_add_u32 v138, 2, v137
    v_lshrrev_b32 v139, 11, v138
    v_min_u32 v139, 1, v139
    v_lshlrev_b32_e64 v139, 31, v139
    v_bfe_u32 v138, v138, 5, 6
    v_lshl_add_u32 v138, v138, 15, v136
    v_or_b32 v17, v138, v139
    v_and_b32 v136, 31, v1
    v_lshlrev_b32 v136, 4, v136
    v_lshrrev_b32 v137, 5, v1
    v_lshl_add_u32 v136, v137, 10, v136
    v_lshlrev_b32_e64 v88, 11, v140
    v_bfe_u32 v138, v1, 4, 1
    v_lshl_add_u32 v88, v138, 10, v88
    v_lshl_add_u32 v88, v137, 5, v88
    v_add_u32 v88, s83, v88
    v_add_u32 v27, s83, v136
    s_lshl_b32 s81, s50, 1
    s_lshr_b32 s83, s48, 1
    s_add_u32 s81, s81, s83
    s_lshl_b32 s83, s81, 6
    v_add_u32 v88, s83, v88
    s_lshl_b32 s83, s81, 11
    s_add_u32 s83, s83, 4194304
    v_add_u32 v27, s83, v27
    s_lshl_b32 s83, s82, 4
    s_add_u32 s83, s83, s81
    s_lshl_b32 s83, s83, 8
    s_add_u32 s83, s83, 14680064
    v_lshl_add_u32 v28, v1, 2, s83
    s_lshl_b32 s82, s51, 2
    s_add_u32 s82, s82, s48
    s_lshl_b32 s81, s82, 15
    s_add_u32 s81, s81, 4194304
    v_lshl_add_u32 v18, v1, 4, s81
    s_cmp_ge_u32 s52, 14
    s_cselect_b32 s81, 0x80000000, 0
    v_or_b32 v18, s81, v18
    s_lshl_b32 s81, s82, 12
    s_add_u32 s81, s81, 14680064
    v_lshl_add_u32 v24, v1, 4, s81
    s_mul_i32 s81, s82, 57344
    s_lshl_b32 s83, s52, 12
    s_add_u32 s81, s81, s83
    s_add_u32 s81, s81, 6291456
    v_add_u32 v30, s81, v136
    s_lshr_b32 s83, s50, 2
    s_add_u32 s83, s83, s52
    s_lshl_b32 s83, s83, 11
    s_lshl_b32 s81, s82, 15
    s_add_u32 s81, s81, s83
    v_add_u32 v31, s81, v136
    s_cmp_ge_u32 s52, 14
    s_cselect_b32 s81, 0x80000000, 0
    v_or_b32 v31, s81, v31
    s_lshl_b32 s81, s48, 9
    s_add_u32 s81, s81, 158720
    v_lshl_add_u32 v107, v137, 6, s81
    v_lshl_add_u32 v109, v1, 2, s81
    v_lshlrev_b32_e64 v108, 4, v1
    v_add_u32 v108, 156672, v108
    s_lshl_b32 s92, s48, 14
    v_lshlrev_b32 v137, 1, v142
    v_and_b32 v137, 4, v137
    v_and_b32 v136, 1, v143
    v_and_b32_e64 v138, 1, v141
    v_lshl_add_u32 v136, v136, 1, v138
    v_and_b32 v138, 2, v141
    v_add_u32 v139, v138, v137
    v_xor_b32_e64 v136, v136, v139
    v_lshl_add_u32 v138, v138, 2, v142
    v_lshlrev_b32_e64 v138, 7, v138
    v_lshl_add_u32 v136, v136, 4, v138
    v_lshrrev_b32_e64 v138, 1, v143
    v_lshl_add_u32 v144, v138, 3, v136
    s_lshr_b32 s81, s48, 1
    s_lshl_b32 s82, s81, 6
    s_lshl_b32 s81, s81, 11
    v_xor_b32 v90, s82, v144
    v_add_u32 v90, s81, v90
    v_xor_b32 v91, 64, v90
    v_add_u32 v92, 61440, v90
    v_add_u32 v93, 61440, v91
    v_add_u32 v94, 122880, v90
    v_add_u32 v95, 122880, v91
    v_mov_b32 v96, v144
    v_xor_b32 v97, 64, v144
    s_lshl_b32 s81, s48, 12
    s_nop 0
    s_add_u32 s81, s81, 65536
    v_lshl_add_u32 v104, v1, 4, s81
    v_xor_b32 v105, 8192, v104
    s_add_u32 s81, s54, 81920
    v_lshl_add_u32 v110, v1, 4, s81
    v_lshlrev_b32_e64 v102, 4, v141
    v_add_u32 v102, 155648, v102
    v_bfe_u32 v136, v1, 4, 1
    v_add_u32 v136, 0, v136
    v_and_b32 v137, 1, v136
    v_lshrrev_b32_e64 v136, 1, v136
    v_lshl_add_u32 v136, v136, 5, v137
    v_lshl_add_u32 v136, v140, 1, v136
    s_lshl_b32 s81, s49, 6
    v_add_u32 v136, s81, v136
    v_lshrrev_b32 v137, 5, v136
    v_lshlrev_b32 v137, 15, v137
    v_and_b32_e64 v138, 1, v136
    v_lshl_add_u32 v137, v138, 8, v137
    v_bfe_u32 v138, v136, 1, 4
    v_lshl_add_u32 v137, v138, 4, v137
    v_lshrrev_b32_e64 v138, 5, v1
    v_lshl_add_u32 v137, v138, 9, v137
    s_lshl_b32 s81, s50, 2
    s_add_u32 s81, s81, s48
    s_lshl_b32 s81, s81, 10
    s_add_u32 s81, s81, 2097152
    v_add_u32 v86, s81, v137
    v_add_u32 v87, 32768, v86
    v_and_b32 v136, 1, v141
    v_lshlrev_b32 v136, 6, v136
    v_lshl_add_u32 v136, v140, 5, v136
    v_lshrrev_b32_e64 v138, 1, v141
    v_lshl_add_u32 v136, v138, 4, v136
    s_lshl_b32 s81, s48, 2
    s_add_u32 s81, s81, 156672
    v_lshl_add_u32 v106, v136, 2, s81
    v_xor_b32 v136, v140, v141
    v_and_b32 v136, 1, v136
    v_add_u32 v136, -1, v136
    v_and_b32 v36, v32, v136
    v_and_b32 v37, v32, v136
    v_and_b32 v38, v32, v136
    v_and_b32 v39, v32, v136
    v_lshlrev_b32 v137, 2, v141
    v_sub_u32 v136, v140, v137
    s_and_b32 s83, s2, 0xe6
    s_cselect_b32 s83, 0, 0xf149f2ca
    v_sub_u32 v144, 1, v141
    v_ashrrev_i32 v144, 31, v144
    v_subrev_u32 v137, 0, v136
    v_sub_u32 v138, 7, v137
    v_or_b32 v138, v138, v137
    v_ashrrev_i32 v138, 31, v138
    v_and_b32 v112, 0xf149f2ca, v138
    v_sub_u32 v138, -9, v137
    v_ashrrev_i32 v138, 31, v138
    v_and_b32 v116, 0xf149f2ca, v138
    v_or_b32 v124, s83, v116
    v_not_b32 v138, v137
    v_ashrrev_i32 v138, 31, v138
    v_or_b32 v138, v138, v144
    v_and_b32 v138, 0xf149f2ca, v138
    v_or_b32 v120, s83, v138
    v_subrev_u32 v137, 1, v136
    v_sub_u32 v138, 7, v137
    v_or_b32 v138, v138, v137
    v_ashrrev_i32_e64 v138, 31, v138
    v_and_b32 v113, 0xf149f2ca, v138
    v_sub_u32 v138, -9, v137
    v_ashrrev_i32 v138, 31, v138
    v_and_b32 v117, 0xf149f2ca, v138
    v_or_b32 v125, s83, v117
    v_not_b32 v138, v137
    v_ashrrev_i32 v138, 31, v138
    v_or_b32 v138, v138, v144
    v_and_b32 v138, 0xf149f2ca, v138
    v_or_b32 v121, s83, v138
    v_subrev_u32 v137, 2, v136
    v_sub_u32 v138, 7, v137
    v_or_b32 v138, v138, v137
    v_ashrrev_i32_e64 v138, 31, v138
    v_and_b32 v114, 0xf149f2ca, v138
    v_sub_u32 v138, -9, v137
    v_ashrrev_i32 v138, 31, v138
    v_and_b32 v118, 0xf149f2ca, v138
    v_or_b32 v126, s83, v118
    v_not_b32 v138, v137
    v_ashrrev_i32 v138, 31, v138
    v_or_b32 v138, v138, v144
    v_and_b32 v138, 0xf149f2ca, v138
    v_or_b32 v122, s83, v138
    v_subrev_u32 v137, 3, v136
    v_sub_u32 v138, 7, v137
    v_or_b32 v138, v138, v137
    v_ashrrev_i32_e64 v138, 31, v138
    v_and_b32 v115, 0xf149f2ca, v138
    v_sub_u32 v138, -9, v137
    v_ashrrev_i32 v138, 31, v138
    v_and_b32 v119, 0xf149f2ca, v138
    v_or_b32 v127, s83, v119
    v_not_b32 v138, v137
    v_ashrrev_i32 v138, 31, v138
    v_or_b32 v138, v138, v144
    v_and_b32 v138, 0xf149f2ca, v138
    v_or_b32_e64 v123, s83, v138
    s_mov_b32 s81, 0x07060302
    v_ashrrev_i32 v136, 31, v112
    v_ashrrev_i32 v137, 31, v113
    v_perm_b32 v136, v137, v136, s81
    v_not_b32 v128, v136
    v_ashrrev_i32 v136, 31, v114
    v_ashrrev_i32_e64 v137, 31, v115
    v_perm_b32 v136, v137, v136, s81
    v_not_b32 v129, v136
    v_ashrrev_i32 v136, 31, v116
    v_ashrrev_i32_e64 v137, 31, v117
    v_perm_b32 v136, v137, v136, s81
    v_not_b32 v130, v136
    v_ashrrev_i32 v136, 31, v118
    v_ashrrev_i32_e64 v137, 31, v119
    v_perm_b32 v136, v137, v136, s81
    v_not_b32 v131, v136
    v_ashrrev_i32 v136, 31, v120
    v_ashrrev_i32_e64 v137, 31, v121
    v_perm_b32 v136, v137, v136, s81
    v_not_b32 v132, v136
    v_ashrrev_i32 v136, 31, v122
    v_ashrrev_i32_e64 v137, 31, v123
    v_perm_b32 v136, v137, v136, s81
    v_not_b32 v133, v136
    v_ashrrev_i32 v136, 31, v124
    v_ashrrev_i32_e64 v137, 31, v125
    v_perm_b32 v136, v137, v136, s81
    v_not_b32 v134, v136
    v_ashrrev_i32 v136, 31, v126
    v_ashrrev_i32_e64 v137, 31, v127
    v_perm_b32 v136, v137, v136, s81
    v_not_b32 v135, v136
    s_and_b32 s81, s49, 1
    s_lshl_b32 s53, s81, 18
    s_bfe_u32 s49, s2, 0x30003
    s_lshr_b32 s81, s2, 6
    s_lshl_b32 s81, s81, 3
    s_and_b32 s82, s2, 7
    s_add_u32 s81, s81, s82
    s_lshl_b32 s52, s81, 2
    s_add_u32 s52, s52, s48
    s_and_b32 s82, s49, 3
    s_lshl_b32 s82, s82, 7
    s_add_u32 s81, s52, s82
    s_mul_i32 s51, s81, 3584
    s_lshl_b32 s50, s81, 10
    s_mul_i32 s52, s52, 14336
    s_lshr_b32 s81, s2, 3
    s_lshl_b32 s81, s81, 2
    s_add_u32 s81, s81, s48
    s_lshl_b32 s52, s81, 12
    s_and_b32 s81, s2, 1
    s_lshl_b32 s81, s81, 9
    s_add_u32 s52, s52, s81
    s_lshr_b32 s81, s48, 1
    s_lshl_b32 s82, s81, 13
    s_and_b32 s83, s48, 1
    s_lshl_b32 s83, s83, 10
    s_add_u32 s98, s82, s83
    s_lshl_b32 s83, s81, 9
    s_min_u32 s81, s2, 1
    s_lshl_b32 s81, s81, 31
    s_add_u32 s81, s81, 15728640
    v_lshrrev_b32 v136, 2, v0
    v_lshlrev_b32 v136, 8, v136
    v_lshl_add_u32 v136, v143, 4, v136
    v_add_u32 v100, s81, v136
    v_mov_b32 v54, 0
    v_mov_b32 v55, 0
    v_mov_b32 v56, 0
    v_mov_b32_e64 v57, 0
    buffer_store_dwordx4 v[54:57], v100, s[36:39], 0 offen sc1
    buffer_store_dwordx4 v[54:57], v100, s[36:39], 0 offen offset:128 sc1
Lnz:
    v_or_b32 v100, s2, v0
    v_min_u32 v100, 1, v100
    v_lshlrev_b32 v100, 31, v100
    v_lshrrev_b32 v136, 2, v1
    v_lshlrev_b32_e64 v136, 10, v136
    v_lshl_add_u32 v0, v143, 7, v136
    s_add_u32 m0, s99, 4096
    s_nop 0
    buffer_load_dwordx4 v145, s[4:7], s58 offen lds
    s_add_u32 m0, s99, 5120
    s_nop 0
    buffer_load_dwordx4 v146, s[4:7], s58 offen lds
    s_add_u32 m0, s54, 106496
    s_nop 0
    s_nop 0
    buffer_load_dwordx4 v2, s[16:19], s66 offen lds
    s_add_u32 m0, s54, 110592
    s_add_u32 s80, s66, 32768
    buffer_load_dwordx4 v2, s[16:19], s80 offen lds
    s_waitcnt vmcnt(11) lgkmcnt(0)
    s_barrier
    ds_read_b64_tr_b16 a[0:1], v5 offset:8192
    ds_read_b64_tr_b16 a[2:3], v5 offset:8704
    ds_read_b64_tr_b16 a[20:21], v5 offset:12288
    ds_read_b64_tr_b16 a[22:23], v5 offset:12800
    ds_read_b128 a[4:7], v148 offset:0
    ds_read_b128 a[8:11], v150 offset:0
    ds_read_b128 a[12:15], v152 offset:0
    ds_read_b128 a[16:19], v154 offset:0
    ds_read_b128 a[24:27], v149 offset:0
    ds_read_b128 a[28:31], v151 offset:0
    ds_read_b128 a[32:35], v153 offset:0
    ds_read_b128 a[36:39], v155 offset:0
    s_add_u32 m0, s99, 6144
    s_nop 0
    buffer_load_dwordx4 v145, s[4:7], s59 offen lds
    s_add_u32 m0, s99, 7168
    s_nop 0
    buffer_load_dwordx4 v146, s[4:7], s59 offen lds
    s_add_u32 m0, s54, 114688
    s_nop 0
    s_nop 0
    buffer_load_dwordx4 v2, s[16:19], s67 offen lds
    s_add_u32 m0, s54, 118784
    s_add_u32 s80, s67, 32768
    buffer_load_dwordx4 v2, s[16:19], s80 offen lds
    s_waitcnt vmcnt(11) lgkmcnt(4)
    s_barrier
    v_mfma_f32_16x16x32_bf16 v[186:189], a[4:7], a[4:7], 0
    ds_read_b64_tr_b16 a[40:41], v5 offset:16384
    ds_read_b64_tr_b16 a[42:43], v5 offset:16896
    v_mfma_f32_16x16x32_bf16 v[190:193], v[32:35], a[4:7], 0
    ds_read_b64_tr_b16 a[60:61], v5 offset:20480
    s_add_u32 m0, s99, 8192
    v_mfma_f32_16x16x32_bf16 v[182:185], a[0:3], v[32:35], 0
    buffer_load_dwordx4 v145, s[4:7], s60 offen lds
    v_mfma_f32_16x16x32_bf16 v[166:169], a[0:3], a[4:7], 0
    ds_read_b64_tr_b16 a[62:63], v5 offset:20992
    v_mfma_f32_16x16x32_bf16 v[170:173], a[0:3], a[8:11], 0
    ds_read_b128 a[44:47], v148 offset:2048
    s_add_u32 m0, s99, 9216
    v_mfma_f32_16x16x32_bf16 v[174:177], a[0:3], a[12:15], 0
    buffer_load_dwordx4 v146, s[4:7], s60 offen lds
    v_mfma_f32_16x16x32_bf16 v[178:181], a[0:3], a[16:19], 0
    ds_read_b128 a[48:51], v150 offset:2048
    s_waitcnt lgkmcnt(6)
    s_nop 0
    v_mfma_f32_16x16x32_bf16 v[186:189], a[24:27], a[24:27], v[186:189]
    ds_read_b128 a[52:55], v152 offset:2048
    ds_read_b128 a[56:59], v154 offset:2048
    v_mfma_f32_16x16x32_bf16 v[190:193], v[32:35], a[24:27], v[190:193]
    ds_read_b128 a[64:67], v149 offset:2048
    s_add_u32 m0, s54, 122880
    v_mfma_f32_16x16x32_bf16 v[182:185], a[20:23], v[32:35], v[182:185]
    buffer_load_dwordx4 v2, s[16:19], s68 offen lds
    v_mfma_f32_16x16x32_bf16 v[166:169], a[20:23], a[24:27], v[166:169]
    ds_read_b128 a[68:71], v151 offset:2048
    s_add_u32 m0, s54, 126976
    v_mfma_f32_16x16x32_bf16 v[170:173], a[20:23], a[28:31], v[170:173]
    ds_read_b128 a[72:75], v153 offset:2048
    s_add_u32 s80, s68, 32768
    v_mfma_f32_16x16x32_bf16 v[174:177], a[20:23], a[32:35], v[174:177]
    buffer_load_dwordx4 v2, s[16:19], s80 offen lds
    v_mfma_f32_16x16x32_bf16 v[178:181], a[20:23], a[36:39], v[178:181]
    ds_read_b128 a[76:79], v155 offset:2048
    s_waitcnt vmcnt(8) lgkmcnt(4)
    s_barrier
    v_mfma_f32_16x16x32_bf16 v[186:189], a[44:47], a[44:47], v[186:189]
    ds_read_b64_tr_b16 a[0:1], v5 offset:24576
    ds_read_b64_tr_b16 a[2:3], v5 offset:25088
    v_mfma_f32_16x16x32_bf16 v[190:193], v[32:35], a[44:47], v[190:193]
    ds_read_b64_tr_b16 a[20:21], v5 offset:28672
    s_add_u32 m0, s99, 10240
    v_mfma_f32_16x16x32_bf16 v[182:185], a[40:43], v[32:35], v[182:185]
    buffer_load_dwordx4 v145, s[4:7], s61 offen lds
    v_mfma_f32_16x16x32_bf16 v[166:169], a[40:43], a[44:47], v[166:169]
    ds_read_b64_tr_b16 a[22:23], v5 offset:29184
    v_mfma_f32_16x16x32_bf16 v[170:173], a[40:43], a[48:51], v[170:173]
    ds_read_b128 a[4:7], v148 offset:4096
    s_add_u32 m0, s99, 11264
    v_mfma_f32_16x16x32_bf16 v[174:177], a[40:43], a[52:55], v[174:177]
    buffer_load_dwordx4 v146, s[4:7], s61 offen lds
    v_mfma_f32_16x16x32_bf16 v[178:181], a[40:43], a[56:59], v[178:181]
    ds_read_b128 a[8:11], v150 offset:4096
    s_waitcnt lgkmcnt(6)
    s_nop 0
    v_mfma_f32_16x16x32_bf16 v[186:189], a[64:67], a[64:67], v[186:189]
    ds_read_b128 a[12:15], v152 offset:4096
    ds_read_b128 a[16:19], v154 offset:4096
    v_mfma_f32_16x16x32_bf16 v[190:193], v[32:35], a[64:67], v[190:193]
    ds_read_b128 a[24:27], v149 offset:4096
    s_add_u32 m0, s54, 131072
    v_mfma_f32_16x16x32_bf16 v[182:185], a[60:63], v[32:35], v[182:185]
    buffer_load_dwordx4 v2, s[16:19], s69 offen lds
    v_mfma_f32_16x16x32_bf16 v[166:169], a[60:63], a[64:67], v[166:169]
    ds_read_b128 a[28:31], v151 offset:4096
    s_add_u32 m0, s54, 135168
    v_mfma_f32_16x16x32_bf16 v[170:173], a[60:63], a[68:71], v[170:173]
    ds_read_b128 a[32:35], v153 offset:4096
    s_add_u32 s80, s69, 32768
    v_mfma_f32_16x16x32_bf16 v[174:177], a[60:63], a[72:75], v[174:177]
    buffer_load_dwordx4 v2, s[16:19], s80 offen lds
    v_mfma_f32_16x16x32_bf16 v[178:181], a[60:63], a[76:79], v[178:181]
    ds_read_b128 a[36:39], v155 offset:4096
    s_waitcnt vmcnt(8) lgkmcnt(4)
    s_barrier
    v_mfma_f32_16x16x32_bf16 v[186:189], a[4:7], a[4:7], v[186:189]
    ds_read_b64_tr_b16 a[40:41], v5 offset:32768
    ds_read_b64_tr_b16 a[42:43], v5 offset:33280
    v_mfma_f32_16x16x32_bf16 v[190:193], v[32:35], a[4:7], v[190:193]
    ds_read_b64_tr_b16 a[60:61], v6 offset:0
    v_mfma_f32_16x16x32_bf16 v[182:185], a[0:3], v[32:35], v[182:185]
    buffer_store_dword v43, v100, s[40:43], 0 offen sc1
    v_mfma_f32_16x16x32_bf16 v[166:169], a[0:3], a[4:7], v[166:169]
    ds_read_b64_tr_b16 a[62:63], v6 offset:512
    s_add_u32 m0, s99, 12288
    v_mfma_f32_16x16x32_bf16 v[170:173], a[0:3], a[8:11], v[170:173]
    buffer_load_dwordx4 v145, s[4:7], s62 offen lds
    v_mfma_f32_16x16x32_bf16 v[174:177], a[0:3], a[12:15], v[174:177]
    ds_read_b128 a[44:47], v148 offset:6144
    ds_read_b128 a[48:51], v150 offset:6144
    v_mfma_f32_16x16x32_bf16 v[178:181], a[0:3], a[16:19], v[178:181]
    ds_read_b128 a[52:55], v152 offset:6144
    s_add_u32 m0, s99, 13312
    s_waitcnt lgkmcnt(7)
    s_nop 0
    v_mfma_f32_16x16x32_bf16 v[186:189], a[24:27], a[24:27], v[186:189]
    buffer_load_dwordx4 v146, s[4:7], s62 offen lds
    v_mfma_f32_16x16x32_bf16 v[190:193], v[32:35], a[24:27], v[190:193]
    ds_read_b128 a[56:59], v154 offset:6144
    v_mfma_f32_16x16x32_bf16 v[182:185], a[20:23], v[32:35], v[182:185]
    ds_read_b128 a[64:67], v149 offset:6144
    ds_read_b128 a[68:71], v151 offset:6144
    s_add_u32 m0, s54, 139264
    v_mfma_f32_16x16x32_bf16 v[166:169], a[20:23], a[24:27], v[166:169]
    buffer_load_dwordx4 v2, s[16:19], s70 offen lds
    s_add_u32 m0, s54, 143360
    v_mfma_f32_16x16x32_bf16 v[170:173], a[20:23], a[28:31], v[170:173]
    ds_read_b128 a[72:75], v153 offset:6144
    s_add_u32 s80, s70, 32768
    v_mfma_f32_16x16x32_bf16 v[174:177], a[20:23], a[32:35], v[174:177]
    buffer_load_dwordx4 v2, s[16:19], s80 offen lds
    v_mfma_f32_16x16x32_bf16 v[178:181], a[20:23], a[36:39], v[178:181]
    ds_read_b128 a[76:79], v155 offset:6144
    s_waitcnt vmcnt(9) lgkmcnt(4)
    s_barrier
    v_mfma_f32_16x16x32_bf16 v[186:189], a[44:47], a[44:47], v[186:189]
    ds_read_b64_tr_b16 a[0:1], v6 offset:4096
    ds_read_b64_tr_b16 a[2:3], v6 offset:4608
    v_mfma_f32_16x16x32_bf16 v[190:193], v[32:35], a[44:47], v[190:193]
    ds_read_b64_tr_b16 a[20:21], v6 offset:8192
    s_add_u32 m0, s99, 14336
    v_mfma_f32_16x16x32_bf16 v[182:185], a[40:43], v[32:35], v[182:185]
    buffer_load_dwordx4 v145, s[4:7], s63 offen lds
    v_mfma_f32_16x16x32_bf16 v[166:169], a[40:43], a[44:47], v[166:169]
    ds_read_b64_tr_b16 a[22:23], v6 offset:8704
    v_mfma_f32_16x16x32_bf16 v[170:173], a[40:43], a[48:51], v[170:173]
    ds_read_b128 a[4:7], v148 offset:8192
    s_add_u32 m0, s99, 15360
    v_mfma_f32_16x16x32_bf16 v[174:177], a[40:43], a[52:55], v[174:177]
    buffer_load_dwordx4 v146, s[4:7], s63 offen lds
    v_mfma_f32_16x16x32_bf16 v[178:181], a[40:43], a[56:59], v[178:181]
    ds_read_b128 a[8:11], v150 offset:8192
    s_waitcnt lgkmcnt(6)
    s_nop 0
    v_mfma_f32_16x16x32_bf16 v[186:189], a[64:67], a[64:67], v[186:189]
    ds_read_b128 a[12:15], v152 offset:8192
    ds_read_b128 a[16:19], v154 offset:8192
    v_mfma_f32_16x16x32_bf16 v[190:193], v[32:35], a[64:67], v[190:193]
    ds_read_b128 a[24:27], v149 offset:8192
    s_add_u32 m0, s54, 147456
    v_mfma_f32_16x16x32_bf16 v[182:185], a[60:63], v[32:35], v[182:185]
    buffer_load_dwordx4 v2, s[16:19], s71 offen lds
    v_mfma_f32_16x16x32_bf16 v[166:169], a[60:63], a[64:67], v[166:169]
    ds_read_b128 a[28:31], v151 offset:8192
    s_add_u32 m0, s54, 151552
    v_mfma_f32_16x16x32_bf16 v[170:173], a[60:63], a[68:71], v[170:173]
    ds_read_b128 a[32:35], v153 offset:8192
    s_add_u32 s80, s71, 32768
    v_mfma_f32_16x16x32_bf16 v[174:177], a[60:63], a[72:75], v[174:177]
    buffer_load_dwordx4 v2, s[16:19], s80 offen lds
    v_mfma_f32_16x16x32_bf16 v[178:181], a[60:63], a[76:79], v[178:181]
    ds_read_b128 a[36:39], v155 offset:8192
    s_waitcnt vmcnt(9) lgkmcnt(4)
    s_barrier
    v_mfma_f32_16x16x32_bf16 v[186:189], a[4:7], a[4:7], v[186:189]
    ds_read_b64_tr_b16 a[40:41], v6 offset:12288
    ds_read_b64_tr_b16 a[42:43], v6 offset:12800
    s_add_u32 m0, s98, 65536
    v_mfma_f32_16x16x32_bf16 v[190:193], v[32:35], a[4:7], v[190:193]
    ds_read_b64_tr_b16 a[60:61], v6 offset:16384
    s_xor_b32 s80, s56, s83
    s_nop 0
    v_mfma_f32_16x16x32_bf16 v[182:185], a[0:3], v[32:35], v[182:185]
    s_mov_b32 exec_lo, 0xffffff00
    buffer_load_dwordx4 v147, s[4:7], s80 offen lds
    s_mov_b32 exec_lo, -1
    s_nop 0
    v_mfma_f32_16x16x32_bf16 v[166:169], a[0:3], a[4:7], v[166:169]
    ds_read_b64_tr_b16 a[62:63], v6 offset:16896
    s_add_u32 m0, s98, 67584
    v_mfma_f32_16x16x32_bf16 v[170:173], a[0:3], a[8:11], v[170:173]
    ds_read_b128 a[44:47], v148 offset:10240
    s_xor_b32 s80, s57, s83
    s_nop 0
    v_mfma_f32_16x16x32_bf16 v[174:177], a[0:3], a[12:15], v[174:177]
    s_mov_b32 exec_lo, 0xffffff00
    buffer_load_dwordx4 v147, s[4:7], s80 offen lds
    s_mov_b32 exec_lo, -1
    v_mfma_f32_16x16x32_bf16 v[178:181], a[0:3], a[16:19], v[178:181]
    ds_read_b128 a[48:51], v150 offset:10240
    s_waitcnt lgkmcnt(6)
    v_mfma_f32_16x16x32_bf16 v[186:189], a[24:27], a[24:27], v[186:189]
    ds_read_b128 a[52:55], v152 offset:10240
    ds_read_b128 a[56:59], v154 offset:10240
    s_add_u32 m0, s98, 69632
    v_mfma_f32_16x16x32_bf16 v[190:193], v[32:35], a[24:27], v[190:193]
    ds_read_b128 a[64:67], v149 offset:10240
    s_xor_b32 s80, s58, s83
    s_nop 0
    v_mfma_f32_16x16x32_bf16 v[182:185], a[20:23], v[32:35], v[182:185]
    s_mov_b32 exec_lo, 0xffffff00
    buffer_load_dwordx4 v147, s[4:7], s80 offen lds
    s_mov_b32 exec_lo, -1
    s_nop 0
    v_mfma_f32_16x16x32_bf16 v[166:169], a[20:23], a[24:27], v[166:169]
    ds_read_b128 a[68:71], v151 offset:10240
    s_add_u32 m0, s98, 71680
    v_mfma_f32_16x16x32_bf16 v[170:173], a[20:23], a[28:31], v[170:173]
    ds_read_b128 a[72:75], v153 offset:10240
    s_xor_b32 s80, s59, s83
    s_nop 0
    v_mfma_f32_16x16x32_bf16 v[174:177], a[20:23], a[32:35], v[174:177]
    s_mov_b32 exec_lo, 0xffffff00
    buffer_load_dwordx4 v147, s[4:7], s80 offen lds
    s_mov_b32 exec_lo, -1
    v_mfma_f32_16x16x32_bf16 v[178:181], a[20:23], a[36:39], v[178:181]
    ds_read_b128 a[76:79], v155 offset:10240
    s_waitcnt vmcnt(8) lgkmcnt(4)
    s_barrier
    s_nop 0
    v_mfma_f32_16x16x32_bf16 v[186:189], a[44:47], a[44:47], v[186:189]
    ds_read_b64_tr_b16 a[0:1], v6 offset:20480
    ds_read_b64_tr_b16 a[2:3], v6 offset:20992
    v_mfma_f32_16x16x32_bf16 v[190:193], v[32:35], a[44:47], v[190:193]
    ds_read_b64_tr_b16 a[20:21], v6 offset:24576
    s_add_u32 m0, s54, 81920
    v_mfma_f32_16x16x32_bf16 v[182:185], a[40:43], v[32:35], v[182:185]
    buffer_load_dwordx4 v3, s[8:11], s72 offen lds
    v_mfma_f32_16x16x32_bf16 v[166:169], a[40:43], a[44:47], v[166:169]
    ds_read_b64_tr_b16 a[22:23], v6 offset:25088
    s_add_u32 m0, s54, 86016
    v_mfma_f32_16x16x32_bf16 v[170:173], a[40:43], a[48:51], v[170:173]
    ds_read_b128 a[4:7], v148 offset:12288
    s_add_u32 s80, s72, 1024
    v_mfma_f32_16x16x32_bf16 v[174:177], a[40:43], a[52:55], v[174:177]
    buffer_load_dwordx4 v3, s[8:11], s80 offen lds
    v_mfma_f32_16x16x32_bf16 v[178:181], a[40:43], a[56:59], v[178:181]
    ds_read_b128 a[8:11], v150 offset:12288
    s_waitcnt lgkmcnt(6)
    s_nop 0
    v_mfma_f32_16x16x32_bf16 v[186:189], a[64:67], a[64:67], v[186:189]
    ds_read_b128 a[12:15], v152 offset:12288
    ds_read_b128 a[16:19], v154 offset:12288
    s_add_u32 m0, s54, 90112
    v_mfma_f32_16x16x32_bf16 v[190:193], v[32:35], a[64:67], v[190:193]
    ds_read_b128 a[24:27], v149 offset:12288
    s_add_u32 s80, s72, 2048
    v_mfma_f32_16x16x32_bf16 v[182:185], a[60:63], v[32:35], v[182:185]
    buffer_load_dwordx4 v3, s[8:11], s80 offen lds
    v_mfma_f32_16x16x32_bf16 v[166:169], a[60:63], a[64:67], v[166:169]
    ds_read_b128 a[28:31], v151 offset:12288
    s_add_u32 m0, s54, 94208
    v_mfma_f32_16x16x32_bf16 v[170:173], a[60:63], a[68:71], v[170:173]
    ds_read_b128 a[32:35], v153 offset:12288
    s_add_u32 s80, s72, 98304
    v_mfma_f32_16x16x32_bf16 v[174:177], a[60:63], a[72:75], v[174:177]
    buffer_load_dwordx4 v3, s[8:11], s80 offen lds
    v_mfma_f32_16x16x32_bf16 v[178:181], a[60:63], a[76:79], v[178:181]
    ds_read_b128 a[36:39], v155 offset:12288
    s_waitcnt vmcnt(8) lgkmcnt(4)
    s_barrier
    v_mfma_f32_16x16x32_bf16 v[186:189], a[4:7], a[4:7], v[186:189]
    ds_read_b64_tr_b16 a[40:41], v6 offset:28672
    ds_read_b64_tr_b16 a[42:43], v6 offset:29184
    s_add_u32 m0, s54, 98304
    v_mfma_f32_16x16x32_bf16 v[190:193], v[32:35], a[4:7], v[190:193]
    ds_read_b64_tr_b16 a[60:61], v6 offset:32768
    s_add_u32 s80, s72, 99328
    v_mfma_f32_16x16x32_bf16 v[182:185], a[0:3], v[32:35], v[182:185]
    buffer_load_dwordx4 v3, s[8:11], s80 offen lds
    v_mfma_f32_16x16x32_bf16 v[166:169], a[0:3], a[4:7], v[166:169]
    ds_read_b64_tr_b16 a[62:63], v6 offset:33280
    s_add_u32 m0, s54, 102400
    v_mfma_f32_16x16x32_bf16 v[170:173], a[0:3], a[8:11], v[170:173]
    ds_read_b128 a[44:47], v148 offset:14336
    s_add_u32 s80, s72, 100352
    v_mfma_f32_16x16x32_bf16 v[174:177], a[0:3], a[12:15], v[174:177]
    buffer_load_dwordx4 v3, s[8:11], s80 offen lds
    v_mfma_f32_16x16x32_bf16 v[178:181], a[0:3], a[16:19], v[178:181]
    ds_read_b128 a[48:51], v150 offset:14336
    s_waitcnt lgkmcnt(6)
    s_nop 0
    v_mfma_f32_16x16x32_bf16 v[186:189], a[24:27], a[24:27], v[186:189]
    ds_read_b128 a[52:55], v152 offset:14336
    ds_read_b128 a[56:59], v154 offset:14336
    v_mfma_f32_16x16x32_bf16 v[190:193], v[32:35], a[24:27], v[190:193]
    ds_read_b128 a[64:67], v149 offset:14336
    s_add_u32 m0, s54, 106496
    v_mfma_f32_16x16x32_bf16 v[182:185], a[20:23], v[32:35], v[182:185]
    buffer_load_dwordx4 v3, s[8:11], s73 offen lds
    v_mfma_f32_16x16x32_bf16 v[166:169], a[20:23], a[24:27], v[166:169]
    ds_read_b128 a[68:71], v151 offset:14336
    s_add_u32 m0, s54, 110592
    v_mfma_f32_16x16x32_bf16 v[170:173], a[20:23], a[28:31], v[170:173]
    ds_read_b128 a[72:75], v153 offset:14336
    s_add_u32 s80, s73, 1024
    v_mfma_f32_16x16x32_bf16 v[174:177], a[20:23], a[32:35], v[174:177]
    buffer_load_dwordx4 v3, s[8:11], s80 offen lds
    v_mfma_f32_16x16x32_bf16 v[178:181], a[20:23], a[36:39], v[178:181]
    ds_read_b128 a[76:79], v155 offset:14336
    s_waitcnt lgkmcnt(4)
    s_nop 0
    v_mfma_f32_16x16x32_bf16 v[186:189], a[44:47], a[44:47], v[186:189]
    s_add_u32 m0, s54, 114688
    v_mfma_f32_16x16x32_bf16 v[190:193], v[32:35], a[44:47], v[190:193]
    s_add_u32 s80, s73, 2048
    s_waitcnt lgkmcnt(0)
    s_nop 0
    v_mfma_f32_16x16x32_bf16 v[186:189], a[64:67], a[64:67], v[186:189]
    buffer_load_dwordx4 v3, s[8:11], s80 offen lds
    v_mfma_f32_16x16x32_bf16 v[190:193], v[32:35], a[64:67], v[190:193]
    v_mfma_f32_16x16x32_bf16 v[182:185], a[40:43], v[32:35], v[182:185]
    s_add_u32 m0, s54, 118784
    v_mfma_f32_16x16x32_bf16 v[166:169], a[40:43], a[44:47], v[166:169]
    s_add_u32 s80, s73, 98304
    v_mfma_f32_16x16x32_bf16 v[170:173], a[40:43], a[48:51], v[170:173]
    buffer_load_dwordx4 v3, s[8:11], s80 offen lds
    v_mfma_f32_16x16x32_bf16 v[174:177], a[40:43], a[52:55], v[174:177]
    v_mfma_f32_16x16x32_bf16 v[178:181], a[40:43], a[56:59], v[178:181]
    v_cndmask_b32 v194, v186, v187, s[84:85]
    v_cndmask_b32 v194, v194, v188, s[86:87]
    v_mfma_f32_16x16x32_bf16 v[182:185], a[60:63], v[32:35], v[182:185]
    v_cndmask_b32 v194, v194, v189, s[88:89]
    v_mul_f32 v195, 0x3b000000, v190
    v_mfma_f32_16x16x32_bf16 v[166:169], a[60:63], a[64:67], v[166:169]
    v_mul_f32 v194, 0x3b000000, v194
    v_fma_f32 v196, -v195, v195, v194
    v_mfma_f32_16x16x32_bf16 v[170:173], a[60:63], a[68:71], v[170:173]
    v_max_f32_e64 v196, 0, v196
    v_add_f32 v197, 0x3727c5ac, v196
    v_mfma_f32_16x16x32_bf16 v[174:177], a[60:63], a[72:75], v[174:177]
    v_rsq_f32 v197, v197
    s_nop 0
    v_mul_f32_e64 v196, v196, v197
    v_mfma_f32_16x16x32_bf16 v[178:181], a[60:63], a[76:79], v[178:181]
    v_mul_f32_e64 v196, v196, v197
    v_add_f32 v196, 0x3727c5ac, v196
    v_rsq_f32 v196, v196
    s_nop 0
    v_mul_f32 v196, v196, v197
    s_mov_b64 exec, s[90:91]
    ds_write_b32 v156, v195 offset:0
    ds_write_b32 v156, v196 offset:640
    ds_write_b32 v156, v197 offset:320
    s_mov_b64 exec, -1
    s_and_b32 s81, s2, 6
    s_lshl_b32 s81, s81, 2
    s_bfe_u32 s82, s2, 0x30005
    s_add_u32 s81, s81, s82
    s_lshl_b32 s64, s81, 9
    s_nop 0
    s_add_u32 s64, s64, 15728640
    s_xor_b32 s65, s64, 512
    s_andn2_b32 s68, s64, 512
    s_and_b32 s82, s2, 1
    s_lshl_b32 s82, s82, 9
    s_add_u32 s67, s68, s82
    s_lshl_b32 s66, s64, 1
    s_sub_u32 s66, s66, s65
    s_and_b32 s66, s66, 0x3e00
    s_add_u32 s66, s66, 15728640
    s_lshr_b32 s82, s82, 5
    s_bfe_u32 s81, s2, 0x20003
    s_lshl_b32 s81, s81, 2
    s_add_u32 s81, s81, s82
    s_add_u32 s57, s64, s81
    s_xor_b32 s58, s57, 512
    s_waitcnt lgkmcnt(0)
    s_barrier
    s_nop 0
    ds_read2_b32 v[198:199], v156 offset0:0 offset1:160
    ds_read2_b32 v[200:201], v157 offset0:0 offset1:160
    ds_read2_b32 v[202:203], v158 offset0:0 offset1:160
    ds_read2_b32 v[204:205], v159 offset0:0 offset1:160
    ds_read_b128 v[46:49], v162
    ds_read_b128 v[50:53], v163
    ds_read2_b32 v[44:45], v164 offset0:0 offset1:80
    s_waitcnt lgkmcnt(6)
    s_nop 0
    s_add_u32 m0, s54, 122880
    v_pk_fma_f32 v[166:167], v[182:183], v[198:199], v[166:167] op_sel:[0,0,0] op_sel_hi:[1,0,1] neg_lo:[0,1,0] neg_hi:[0,1,0]
    v_pk_fma_f32 v[168:169], v[184:185], v[198:199], v[168:169] op_sel:[0,0,0] op_sel_hi:[1,0,1] neg_lo:[0,1,0] neg_hi:[0,1,0]
    v_pk_mul_f32 v[166:167], v[166:167], v[198:199] op_sel:[0,1] op_sel_hi:[1,1]
    s_add_u32 s80, s73, 99328
    v_pk_mul_f32 v[168:169], v[168:169], v[198:199] op_sel:[0,1] op_sel_hi:[1,1]
    s_waitcnt lgkmcnt(5)
    s_nop 0
    v_pk_fma_f32 v[170:171], v[182:183], v[200:201], v[170:171] op_sel:[0,0,0] op_sel_hi:[1,0,1] neg_lo:[0,1,0] neg_hi:[0,1,0]
    v_pk_fma_f32 v[172:173], v[184:185], v[200:201], v[172:173] op_sel:[0,0,0] op_sel_hi:[1,0,1] neg_lo:[0,1,0] neg_hi:[0,1,0]
    buffer_load_dwordx4 v3, s[8:11], s80 offen lds
    v_pk_mul_f32 v[170:171], v[170:171], v[200:201] op_sel:[0,1] op_sel_hi:[1,1]
    v_pk_mul_f32 v[172:173], v[172:173], v[200:201] op_sel:[0,1] op_sel_hi:[1,1]
    s_waitcnt lgkmcnt(4)
    s_nop 0
    v_pk_fma_f32 v[174:175], v[182:183], v[202:203], v[174:175] op_sel:[0,0,0] op_sel_hi:[1,0,1] neg_lo:[0,1,0] neg_hi:[0,1,0]
    s_add_u32 m0, s54, 126976
    v_pk_fma_f32 v[176:177], v[184:185], v[202:203], v[176:177] op_sel:[0,0,0] op_sel_hi:[1,0,1] neg_lo:[0,1,0] neg_hi:[0,1,0]
    v_pk_mul_f32 v[174:175], v[174:175], v[202:203] op_sel:[0,1] op_sel_hi:[1,1]
    v_pk_mul_f32 v[176:177], v[176:177], v[202:203] op_sel:[0,1] op_sel_hi:[1,1]
    s_waitcnt lgkmcnt(3)
    s_nop 0
    s_add_u32 s80, s73, 100352
    v_pk_fma_f32 v[178:179], v[182:183], v[204:205], v[178:179] op_sel:[0,0,0] op_sel_hi:[1,0,1] neg_lo:[0,1,0] neg_hi:[0,1,0]
    v_pk_fma_f32 v[180:181], v[184:185], v[204:205], v[180:181] op_sel:[0,0,0] op_sel_hi:[1,0,1] neg_lo:[0,1,0] neg_hi:[0,1,0]
    v_pk_mul_f32 v[178:179], v[178:179], v[204:205] op_sel:[0,1] op_sel_hi:[1,1]
    v_pk_mul_f32 v[180:181], v[180:181], v[204:205] op_sel:[0,1] op_sel_hi:[1,1]
    buffer_load_dwordx4 v3, s[8:11], s80 offen lds
    v_pk_mul_f32 v[206:207], v[166:167], v[166:167]
    v_pk_mul_f32 v[208:209], v[168:169], v[168:169]
    v_pk_mul_f32 v[210:211], v[170:171], v[170:171]
    v_pk_mul_f32 v[212:213], v[172:173], v[172:173]
    s_add_u32 m0, s54, 131072
    v_pk_mul_f32 v[214:215], v[174:175], v[174:175]
    v_pk_mul_f32 v[216:217], v[176:177], v[176:177]
    v_pk_mul_f32 v[218:219], v[178:179], v[178:179]
    v_pk_mul_f32 v[220:221], v[180:181], v[180:181]
    v_pk_fma_f32 v[206:207], v[206:207], s[100:101], v[40:41]
    v_pk_fma_f32 v[208:209], v[208:209], s[100:101], v[40:41]
    v_pk_fma_f32 v[210:211], v[210:211], s[100:101], v[40:41]
    buffer_load_dwordx4 v3, s[8:11], s74 offen lds
    v_pk_fma_f32 v[212:213], v[212:213], s[100:101], v[40:41]
    v_pk_fma_f32 v[214:215], v[214:215], s[100:101], v[40:41]
    v_pk_fma_f32 v[216:217], v[216:217], s[100:101], v[40:41]
    v_pk_fma_f32 v[218:219], v[218:219], s[100:101], v[40:41]
    v_pk_fma_f32 v[220:221], v[220:221], s[100:101], v[40:41]
    v_pk_mul_f32 v[206:207], v[206:207], v[166:167]
    s_add_u32 m0, s54, 135168
    v_pk_mul_f32 v[208:209], v[208:209], v[168:169]
    v_pk_mul_f32 v[210:211], v[210:211], v[170:171]
    v_pk_mul_f32 v[212:213], v[212:213], v[172:173]
    v_pk_mul_f32 v[214:215], v[214:215], v[174:175]
    s_add_u32 s80, s74, 1024
    v_pk_mul_f32 v[216:217], v[216:217], v[176:177]
    v_pk_mul_f32 v[218:219], v[218:219], v[178:179]
    v_pk_mul_f32 v[220:221], v[220:221], v[180:181]
    v_exp_f32_e64 v206, v206
    buffer_load_dwordx4 v3, s[8:11], s80 offen lds
    v_exp_f32 v207, v207
    v_exp_f32 v208, v208
    s_add_u32 m0, s54, 139264
    v_exp_f32 v209, v209
    v_exp_f32 v210, v210
    s_add_u32 s80, s74, 2048
    v_exp_f32 v211, v211
    v_exp_f32 v212, v212
    buffer_load_dwordx4 v3, s[8:11], s80 offen lds
    v_exp_f32 v213, v213
    v_exp_f32 v214, v214
    s_add_u32 m0, s54, 143360
    v_exp_f32 v215, v215
    v_exp_f32 v216, v216
    s_add_u32 s80, s74, 98304
    v_exp_f32 v217, v217
    v_exp_f32 v218, v218
    buffer_load_dwordx4 v3, s[8:11], s80 offen lds
    v_exp_f32 v219, v219
    v_exp_f32 v220, v220
    s_add_u32 m0, s54, 147456
    v_exp_f32_e64 v221, v221
    v_pk_add_f32 v[206:207], v[206:207], 1.0 op_sel_hi:[1,0]
    s_add_u32 s80, s74, 99328
    v_pk_add_f32 v[208:209], v[208:209], 1.0 op_sel_hi:[1,0]
    v_pk_add_f32 v[210:211], v[210:211], 1.0 op_sel_hi:[1,0]
    v_pk_add_f32 v[212:213], v[212:213], 1.0 op_sel_hi:[1,0]
    v_pk_add_f32 v[214:215], v[214:215], 1.0 op_sel_hi:[1,0]
    buffer_load_dwordx4 v3, s[8:11], s80 offen lds
    v_pk_add_f32 v[216:217], v[216:217], 1.0 op_sel_hi:[1,0]
    v_pk_add_f32 v[218:219], v[218:219], 1.0 op_sel_hi:[1,0]
    v_pk_add_f32 v[220:221], v[220:221], 1.0 op_sel_hi:[1,0]
    v_rcp_f32_e64 v206, v206
    s_add_u32 m0, s54, 151552
    v_rcp_f32 v207, v207
    v_rcp_f32 v208, v208
    s_add_u32 s80, s74, 100352
    v_rcp_f32 v209, v209
    v_rcp_f32 v210, v210
    buffer_load_dwordx4 v3, s[8:11], s80 offen lds
    v_rcp_f32 v211, v211
    v_rcp_f32 v212, v212
    v_rcp_f32 v213, v213
    v_rcp_f32 v214, v214
    v_rcp_f32 v215, v215
    v_rcp_f32 v216, v216
    v_rcp_f32 v217, v217
    v_rcp_f32 v218, v218
    v_rcp_f32 v219, v219
    v_rcp_f32 v220, v220
    v_rcp_f32_e64 v221, v221
    v_pk_mul_f32 v[166:167], v[166:167], v[206:207]
    v_pk_mul_f32 v[168:169], v[168:169], v[208:209]
    v_pk_mul_f32 v[170:171], v[170:171], v[210:211]
    v_pk_mul_f32 v[172:173], v[172:173], v[212:213]
    v_pk_mul_f32 v[174:175], v[174:175], v[214:215]
    v_pk_mul_f32 v[176:177], v[176:177], v[216:217]
    v_pk_mul_f32 v[178:179], v[178:179], v[218:219]
    v_pk_mul_f32 v[180:181], v[180:181], v[220:221]
    v_cvt_pk_bf16_f32 v70, v166, v167
    v_cvt_pk_bf16_f32 v71, v168, v169
    v_cvt_pk_bf16_f32 v72, v170, v171
    v_cvt_pk_bf16_f32 v73, v172, v173
    v_cvt_pk_bf16_f32 v74, v174, v175
    v_cvt_pk_bf16_f32 v75, v176, v177
    v_cvt_pk_bf16_f32 v76, v178, v179
    v_cvt_pk_bf16_f32 v77, v180, v181
    v_mov_b32 v78, v160
    v_mov_b32 v79, v161
    v_permlane16_swap_b32 v70, v72
    v_permlane16_swap_b32 v71, v73
    v_permlane16_swap_b32 v74, v76
    v_permlane16_swap_b32 v75, v77
    buffer_store_dwordx4 v[70:73], v78, s[36:39], 0 offen sc1
    buffer_store_dwordx4 v[74:77], v79, s[36:39], 0 offen sc1
    s_waitcnt vmcnt(17)
    s_barrier
    ds_read_b128 a[88:91], v8 offset:0
    ds_read_b128 a[92:95], v8 offset:16384
    ds_read_b128 a[96:99], v8 offset:32768
    ds_read_b128 a[100:103], v8 offset:49152
    ds_read_b128 a[104:107], v10 offset:0
    ds_read_b64_tr_b16 a[64:65], v5 offset:0
    ds_read_b64_tr_b16 a[66:67], v5 offset:512
    ds_read_b64_tr_b16 a[68:69], v5 offset:4096
    ds_read_b64_tr_b16 a[70:71], v5 offset:4608
    ds_read_b64_tr_b16 a[72:73], v5 offset:8192
    ds_read_b64_tr_b16 a[74:75], v5 offset:8704
    ds_read_b128 a[108:111], v9 offset:0
    ds_read_b128 a[112:115], v9 offset:16384
    ds_read_b128 a[116:119], v9 offset:32768
    ds_read_b128 a[120:123], v9 offset:49152
    ds_read_b128 a[124:127], v11 offset:0
    s_waitcnt vmcnt(14) lgkmcnt(5)
    s_barrier
    v_mfma_f32_16x16x32_bf16 v[206:209], a[104:107], a[104:107], 0
    ds_read_b64_tr_b16 a[76:77], v5 offset:12288
    s_lshr_b32 s81, s53, 18
    s_nop 0
    v_mfma_f32_16x16x32_bf16 v[146:149], a[64:67], a[88:91], 0
    ds_read_b64_tr_b16 a[78:79], v5 offset:12800
    s_mul_i32 s99, s81, 917504
    v_mfma_f32_16x16x32_bf16 v[150:153], a[64:67], a[92:95], 0
    s_cmp_lg_u32 s48, 3
    s_cbranch_scc1 Lpi1
    s_load_dword s69, s[40:41], 0
Lpi1:
    s_cmp_eq_u32 s49, 7
    s_cselect_b64 s[4:5], s[12:13], s[24:25]
    s_cselect_b32 s6, s14, s26
    s_nop 0
    v_mfma_f32_16x16x32_bf16 v[154:157], a[64:67], a[96:99], 0
    ds_read_b64_tr_b16 a[80:81], v5 offset:16384
    s_mov_b32 s82, 114688
    v_mfma_f32_16x16x32_bf16 v[158:161], a[64:67], a[100:103], 0
    ds_read_b64_tr_b16 a[82:83], v5 offset:16896
    s_mov_b32 s83, 0xffe5c080
    v_mfma_f32_16x16x32_bf16 v[162:165], a[68:71], a[88:91], 0
    ds_read_b64_tr_b16 a[84:85], v5 offset:20480
    s_add_u32 m0, s54, 81920
    v_mfma_f32_16x16x32_bf16 v[166:169], a[68:71], a[92:95], 0
    buffer_load_dwordx4 v3, s[8:11], s75 offen lds
    s_cmp_eq_u32 s49, 7
    s_nop 0
    s_cselect_b32 s16, 32768, s82
    s_cselect_b32 s17, 163840, s82
    v_mfma_f32_16x16x32_bf16 v[170:173], a[68:71], a[96:99], 0
    ds_read_b64_tr_b16 a[86:87], v5 offset:20992
    s_cmp_eq_u32 s49, 7
    s_nop 0
    s_cselect_b32 s18, 0xfffa8080, s82
    s_cselect_b32 s19, 0xfffa8080, s83
    v_mfma_f32_16x16x32_bf16 v[174:177], a[68:71], a[100:103], 0
    ds_read_b128 a[128:131], v8 offset:2048
    s_add_u32 m0, s54, 86016
    v_mfma_f32_16x16x32_bf16 v[178:181], a[68:71], a[104:107], 0
    ds_read_b128 a[132:135], v8 offset:18432
    s_add_u32 s80, s75, 1024
    v_mfma_f32_16x16x32_bf16 v[182:185], a[88:91], a[72:75], 0
    buffer_load_dwordx4 v3, s[8:11], s80 offen lds
    s_cmp_eq_u32 s49, 7
    s_nop 0
    s_cselect_b32 s56, 131072, 0
    v_mfma_f32_16x16x32_bf16 v[186:189], a[92:95], a[72:75], 0
    ds_read_b128 a[136:139], v8 offset:34816
    v_mfma_f32_16x16x32_bf16 v[190:193], a[96:99], a[72:75], 0
    ds_read_b128 a[140:143], v8 offset:51200
    s_add_u32 m0, s54, 90112
    v_mfma_f32_16x16x32_bf16 v[194:197], a[100:103], a[72:75], 0
    ds_read_b128 a[144:147], v10 offset:2048
    s_add_u32 s80, s75, 2048
    v_mfma_f32_16x16x32_bf16 v[198:201], a[104:107], a[72:75], 0
    buffer_load_dwordx4 v3, s[8:11], s80 offen lds
    v_mfma_f32_16x16x32_bf16 v[202:205], a[64:67], v[32:35], 0
    s_waitcnt vmcnt(14) lgkmcnt(5)
    s_barrier
    v_mfma_f32_16x16x32_bf16 v[206:209], a[124:127], a[124:127], v[206:209]
    ds_read_b64_tr_b16 a[64:65], v5 offset:24576
    s_add_u32 m0, s54, 94208
    v_mfma_f32_16x16x32_bf16 v[146:149], a[76:79], a[108:111], v[146:149]
    ds_read_b64_tr_b16 a[66:67], v5 offset:25088
    s_add_u32 s80, s75, 98304
    v_mfma_f32_16x16x32_bf16 v[150:153], a[76:79], a[112:115], v[150:153]
    buffer_load_dwordx4 v3, s[8:11], s80 offen lds
    s_cmp_eq_u32 s49, 0
    s_cbranch_scc1 Lt22
Lt2b3:
    v_mfma_f32_16x16x32_bf16 v[154:157], a[76:79], a[116:119], v[154:157]
    ds_read_b64_tr_b16 a[68:69], v5 offset:28672
    v_mfma_f32_16x16x32_bf16 v[158:161], a[76:79], a[120:123], v[158:161]
    ds_read_b64_tr_b16 a[70:71], v5 offset:29184
    v_mfma_f32_16x16x32_bf16 v[162:165], a[80:83], a[108:111], v[162:165]
    ds_read_b64_tr_b16 a[72:73], v5 offset:32768
    v_mfma_f32_16x16x32_bf16 v[166:169], a[80:83], a[112:115], v[166:169]
    ds_read_b64_tr_b16 a[74:75], v5 offset:33280
    s_add_u32 m0, s54, 98304
    v_mfma_f32_16x16x32_bf16 v[170:173], a[80:83], a[116:119], v[170:173]
    ds_read_b128 a[88:91], v9 offset:2048
    s_add_u32 s80, s75, 99328
    v_mfma_f32_16x16x32_bf16 v[174:177], a[80:83], a[120:123], v[174:177]
    buffer_load_dwordx4 v3, s[8:11], s80 offen lds
    v_mfma_f32_16x16x32_bf16 v[178:181], a[80:83], a[124:127], v[178:181]
    ds_read_b128 a[92:95], v9 offset:18432
    v_mfma_f32_16x16x32_bf16 v[182:185], a[108:111], a[84:87], v[182:185]
    ds_read_b128 a[96:99], v9 offset:34816
    v_mfma_f32_16x16x32_bf16 v[186:189], a[112:115], a[84:87], v[186:189]
    ds_read_b128 a[100:103], v9 offset:51200
    v_mfma_f32_16x16x32_bf16 v[190:193], a[116:119], a[84:87], v[190:193]
    ds_read_b128 a[104:107], v11 offset:2048
    s_add_u32 m0, s54, 102400
    v_mfma_f32_16x16x32_bf16 v[194:197], a[120:123], a[84:87], v[194:197]
    s_add_u32 s80, s75, 100352
    v_mfma_f32_16x16x32_bf16 v[198:201], a[124:127], a[84:87], v[198:201]
    buffer_load_dwordx4 v3, s[8:11], s80 offen lds
    v_mfma_f32_16x16x32_bf16 v[202:205], a[76:79], v[32:35], v[202:205]
    s_waitcnt vmcnt(14) lgkmcnt(5)
    s_barrier
    v_mfma_f32_16x16x32_bf16 v[206:209], a[144:147], a[144:147], v[206:209]
    ds_read_b64_tr_b16 a[76:77], v6 offset:0
    s_cmp_eq_u32 s49, 1
    s_cbranch_scc1 Lt24
Lt2b5:
    v_mfma_f32_16x16x32_bf16 v[146:149], a[64:67], a[128:131], v[146:149]
    ds_read_b64_tr_b16 a[78:79], v6 offset:512
    s_add_u32 m0, s54, 106496
    v_mfma_f32_16x16x32_bf16 v[150:153], a[64:67], a[132:135], v[150:153]
    buffer_load_dwordx4 v3, s[8:11], s76 offen lds
    v_mfma_f32_16x16x32_bf16 v[154:157], a[64:67], a[136:139], v[154:157]
    ds_read_b64_tr_b16 a[80:81], v6 offset:4096
    v_mfma_f32_16x16x32_bf16 v[158:161], a[64:67], a[140:143], v[158:161]
    ds_read_b64_tr_b16 a[82:83], v6 offset:4608
    v_mfma_f32_16x16x32_bf16 v[162:165], a[68:71], a[128:131], v[162:165]
    ds_read_b64_tr_b16 a[84:85], v6 offset:8192
    v_mfma_f32_16x16x32_bf16 v[166:169], a[68:71], a[132:135], v[166:169]
    ds_read_b64_tr_b16 a[86:87], v6 offset:8704
    s_add_u32 m0, s54, 110592
    v_mfma_f32_16x16x32_bf16 v[170:173], a[68:71], a[136:139], v[170:173]
    ds_read_b128 a[108:111], v8 offset:4096
    s_add_u32 s80, s76, 1024
    v_mfma_f32_16x16x32_bf16 v[174:177], a[68:71], a[140:143], v[174:177]
    buffer_load_dwordx4 v3, s[8:11], s80 offen lds
    v_mfma_f32_16x16x32_bf16 v[178:181], a[68:71], a[144:147], v[178:181]
    ds_read_b128 a[112:115], v8 offset:20480
    v_mfma_f32_16x16x32_bf16 v[182:185], a[128:131], a[72:75], v[182:185]
    ds_read_b128 a[116:119], v8 offset:36864
    v_mfma_f32_16x16x32_bf16 v[186:189], a[132:135], a[72:75], v[186:189]
    ds_read_b128 a[120:123], v8 offset:53248
    v_mfma_f32_16x16x32_bf16 v[190:193], a[136:139], a[72:75], v[190:193]
    ds_read_b128 a[124:127], v10 offset:4096
    s_add_u32 m0, s54, 114688
    v_mfma_f32_16x16x32_bf16 v[194:197], a[140:143], a[72:75], v[194:197]
    s_add_u32 s80, s76, 2048
    v_mfma_f32_16x16x32_bf16 v[198:201], a[144:147], a[72:75], v[198:201]
    buffer_load_dwordx4 v3, s[8:11], s80 offen lds
    v_mfma_f32_16x16x32_bf16 v[202:205], a[64:67], v[32:35], v[202:205]
    s_cmp_lg_u32 s48, 3
    s_cbranch_scc1 Lpolld7
    s_waitcnt lgkmcnt(0)
    s_cmp_lt_u32 s69, 1
    s_cbranch_scc1 Lpoll6
Lpolld7:
    s_waitcnt vmcnt(9) lgkmcnt(5)
    s_barrier
    v_mfma_f32_16x16x32_bf16 v[206:209], a[104:107], a[104:107], v[206:209]
    ds_read_b64_tr_b16 a[64:65], v6 offset:12288
    s_cmp_eq_u32 s49, 2
    s_cbranch_scc1 Lt29
Lt2b10:
    v_mfma_f32_16x16x32_bf16 v[146:149], a[76:79], a[88:91], v[146:149]
    ds_read_b64_tr_b16 a[66:67], v6 offset:12800
    v_mfma_f32_16x16x32_bf16 v[150:153], a[76:79], a[92:95], v[150:153]
    s_cmp_lg_u32 s48, 0
    s_cbranch_scc1 Lsg8
    s_atomic_add s1, s[36:37], s64 offset:132
Lsg8:
    v_mfma_f32_16x16x32_bf16 v[154:157], a[76:79], a[96:99], v[154:157]
    ds_read_b64_tr_b16 a[68:69], v6 offset:16384
    v_mfma_f32_16x16x32_bf16 v[158:161], a[76:79], a[100:103], v[158:161]
    ds_read_b64_tr_b16 a[70:71], v6 offset:16896
    s_add_u32 m0, s54, 118784
    v_mfma_f32_16x16x32_bf16 v[162:165], a[80:83], a[88:91], v[162:165]
    ds_read_b64_tr_b16 a[72:73], v6 offset:20480
    s_add_u32 s80, s76, 98304
    v_mfma_f32_16x16x32_bf16 v[166:169], a[80:83], a[92:95], v[166:169]
    buffer_load_dwordx4 v3, s[8:11], s80 offen lds
    v_mfma_f32_16x16x32_bf16 v[170:173], a[80:83], a[96:99], v[170:173]
    ds_read_b64_tr_b16 a[74:75], v6 offset:20992
    v_mfma_f32_16x16x32_bf16 v[174:177], a[80:83], a[100:103], v[174:177]
    ds_read_b128 a[128:131], v9 offset:4096
    s_add_u32 m0, s54, 122880
    v_mfma_f32_16x16x32_bf16 v[178:181], a[80:83], a[104:107], v[178:181]
    ds_read_b128 a[132:135], v9 offset:20480
    s_add_u32 s80, s76, 99328
    v_mfma_f32_16x16x32_bf16 v[182:185], a[88:91], a[84:87], v[182:185]
    buffer_load_dwordx4 v3, s[8:11], s80 offen lds
    v_mfma_f32_16x16x32_bf16 v[186:189], a[92:95], a[84:87], v[186:189]
    ds_read_b128 a[136:139], v9 offset:36864
    v_mfma_f32_16x16x32_bf16 v[190:193], a[96:99], a[84:87], v[190:193]
    ds_read_b128 a[140:143], v9 offset:53248
    s_add_u32 m0, s54, 126976
    v_mfma_f32_16x16x32_bf16 v[194:197], a[100:103], a[84:87], v[194:197]
    ds_read_b128 a[144:147], v11 offset:4096
    s_add_u32 s80, s76, 100352
    v_mfma_f32_16x16x32_bf16 v[198:201], a[104:107], a[84:87], v[198:201]
    buffer_load_dwordx4 v3, s[8:11], s80 offen lds
    v_mfma_f32_16x16x32_bf16 v[202:205], a[76:79], v[32:35], v[202:205]
    s_waitcnt lgkmcnt(5)
    s_barrier
    v_mfma_f32_16x16x32_bf16 v[206:209], a[124:127], a[124:127], v[206:209]
    ds_read_b64_tr_b16 a[76:77], v6 offset:24576
    s_cmp_eq_u32 s49, 3
    s_cbranch_scc1 Lt211
Lt2b12:
    v_mfma_f32_16x16x32_bf16 v[146:149], a[64:67], a[108:111], v[146:149]
    ds_read_b64_tr_b16 a[78:79], v6 offset:25088
    s_add_u32 m0, s54, 131072
    v_mfma_f32_16x16x32_bf16 v[150:153], a[64:67], a[112:115], v[150:153]
    buffer_load_dwordx4 v3, s[8:11], s77 offen lds
    v_mfma_f32_16x16x32_bf16 v[154:157], a[64:67], a[116:119], v[154:157]
    ds_read_b64_tr_b16 a[80:81], v6 offset:28672
    v_mfma_f32_16x16x32_bf16 v[158:161], a[64:67], a[120:123], v[158:161]
    ds_read_b64_tr_b16 a[82:83], v6 offset:29184
    v_mfma_f32_16x16x32_bf16 v[162:165], a[68:71], a[108:111], v[162:165]
    ds_read_b64_tr_b16 a[84:85], v6 offset:32768
    v_mfma_f32_16x16x32_bf16 v[166:169], a[68:71], a[112:115], v[166:169]
    ds_read_b64_tr_b16 a[86:87], v6 offset:33280
    s_add_u32 m0, s54, 135168
    v_mfma_f32_16x16x32_bf16 v[170:173], a[68:71], a[116:119], v[170:173]
    ds_read_b128 a[88:91], v8 offset:6144
    s_add_u32 s80, s77, 1024
    v_mfma_f32_16x16x32_bf16 v[174:177], a[68:71], a[120:123], v[174:177]
    buffer_load_dwordx4 v3, s[8:11], s80 offen lds
    v_mfma_f32_16x16x32_bf16 v[178:181], a[68:71], a[124:127], v[178:181]
    ds_read_b128 a[92:95], v8 offset:22528
    v_mfma_f32_16x16x32_bf16 v[182:185], a[108:111], a[72:75], v[182:185]
    ds_read_b128 a[96:99], v8 offset:38912
    v_mfma_f32_16x16x32_bf16 v[186:189], a[112:115], a[72:75], v[186:189]
    ds_read_b128 a[100:103], v8 offset:55296
    v_mfma_f32_16x16x32_bf16 v[190:193], a[116:119], a[72:75], v[190:193]
    ds_read_b128 a[104:107], v10 offset:6144
    s_add_u32 m0, s54, 139264
    v_mfma_f32_16x16x32_bf16 v[194:197], a[120:123], a[72:75], v[194:197]
    s_add_u32 s80, s77, 2048
    v_mfma_f32_16x16x32_bf16 v[198:201], a[124:127], a[72:75], v[198:201]
    buffer_load_dwordx4 v3, s[8:11], s80 offen lds
    v_mfma_f32_16x16x32_bf16 v[202:205], a[64:67], v[32:35], v[202:205]
    s_waitcnt vmcnt(12) lgkmcnt(5)
    s_barrier
    s_nop 0
    v_mfma_f32_16x16x32_bf16 v[206:209], a[144:147], a[144:147], v[206:209]
    ds_read_b64_tr_b16 a[64:65], v5 offset:0
    s_add_u32 m0, s54, 143360
    v_mfma_f32_16x16x32_bf16 v[146:149], a[76:79], a[128:131], v[146:149]
    ds_read_b64_tr_b16 a[66:67], v5 offset:512
    s_add_u32 s80, s77, 98304
    v_mfma_f32_16x16x32_bf16 v[150:153], a[76:79], a[132:135], v[150:153]
    buffer_load_dwordx4 v3, s[8:11], s80 offen lds
    s_cmp_eq_u32 s49, 4
    s_cbranch_scc1 Lt213
Lt2b14:
    v_mfma_f32_16x16x32_bf16 v[154:157], a[76:79], a[136:139], v[154:157]
    ds_read_b64_tr_b16 a[68:69], v5 offset:4096
    v_mfma_f32_16x16x32_bf16 v[158:161], a[76:79], a[140:143], v[158:161]
    ds_read_b64_tr_b16 a[70:71], v5 offset:4608
    v_mfma_f32_16x16x32_bf16 v[162:165], a[80:83], a[128:131], v[162:165]
    ds_read_b64_tr_b16 a[72:73], v5 offset:8192
    v_mfma_f32_16x16x32_bf16 v[166:169], a[80:83], a[132:135], v[166:169]
    ds_read_b64_tr_b16 a[74:75], v5 offset:8704
    s_add_u32 m0, s54, 147456
    v_mfma_f32_16x16x32_bf16 v[170:173], a[80:83], a[136:139], v[170:173]
    ds_read_b128 a[108:111], v9 offset:6144
    s_add_u32 s80, s77, 99328
    v_mfma_f32_16x16x32_bf16 v[174:177], a[80:83], a[140:143], v[174:177]
    buffer_load_dwordx4 v3, s[8:11], s80 offen lds
    v_mfma_f32_16x16x32_bf16 v[178:181], a[80:83], a[144:147], v[178:181]
    ds_read_b128 a[112:115], v9 offset:22528
    v_mfma_f32_16x16x32_bf16 v[182:185], a[128:131], a[84:87], v[182:185]
    ds_read_b128 a[116:119], v9 offset:38912
    v_mfma_f32_16x16x32_bf16 v[186:189], a[132:135], a[84:87], v[186:189]
    ds_read_b128 a[120:123], v9 offset:55296
    v_mfma_f32_16x16x32_bf16 v[190:193], a[136:139], a[84:87], v[190:193]
    ds_read_b128 a[124:127], v11 offset:6144
    s_add_u32 m0, s54, 151552
    v_mfma_f32_16x16x32_bf16 v[194:197], a[140:143], a[84:87], v[194:197]
    s_add_u32 s80, s77, 100352
    v_mfma_f32_16x16x32_bf16 v[198:201], a[144:147], a[84:87], v[198:201]
    buffer_load_dwordx4 v3, s[8:11], s80 offen lds
    v_mfma_f32_16x16x32_bf16 v[202:205], a[76:79], v[32:35], v[202:205]
    s_waitcnt vmcnt(12) lgkmcnt(5)
    s_barrier
    v_mfma_f32_16x16x32_bf16 v[206:209], a[104:107], a[104:107], v[206:209]
    ds_read_b64_tr_b16 a[76:77], v5 offset:12288
    s_cmp_eq_u32 s49, 5
    s_cbranch_scc1 Lt215
Lt2b16:
    v_mfma_f32_16x16x32_bf16 v[146:149], a[64:67], a[88:91], v[146:149]
    ds_read_b64_tr_b16 a[78:79], v5 offset:12800
    s_add_u32 m0, s54, 81920
    v_mfma_f32_16x16x32_bf16 v[150:153], a[64:67], a[92:95], v[150:153]
    buffer_load_dwordx4 v3, s[8:11], s78 offen lds
    v_mfma_f32_16x16x32_bf16 v[154:157], a[64:67], a[96:99], v[154:157]
    ds_read_b64_tr_b16 a[80:81], v5 offset:16384
    v_mfma_f32_16x16x32_bf16 v[158:161], a[64:67], a[100:103], v[158:161]
    ds_read_b64_tr_b16 a[82:83], v5 offset:16896
    v_mfma_f32_16x16x32_bf16 v[162:165], a[68:71], a[88:91], v[162:165]
    ds_read_b64_tr_b16 a[84:85], v5 offset:20480
    v_mfma_f32_16x16x32_bf16 v[166:169], a[68:71], a[92:95], v[166:169]
    ds_read_b64_tr_b16 a[86:87], v5 offset:20992
    s_add_u32 m0, s54, 86016
    v_mfma_f32_16x16x32_bf16 v[170:173], a[68:71], a[96:99], v[170:173]
    ds_read_b128 a[128:131], v8 offset:8192
    s_add_u32 s80, s78, 1024
    v_mfma_f32_16x16x32_bf16 v[174:177], a[68:71], a[100:103], v[174:177]
    buffer_load_dwordx4 v3, s[8:11], s80 offen lds
    v_mfma_f32_16x16x32_bf16 v[178:181], a[68:71], a[104:107], v[178:181]
    ds_read_b128 a[132:135], v8 offset:24576
    v_mfma_f32_16x16x32_bf16 v[182:185], a[88:91], a[72:75], v[182:185]
    ds_read_b128 a[136:139], v8 offset:40960
    v_mfma_f32_16x16x32_bf16 v[186:189], a[92:95], a[72:75], v[186:189]
    ds_read_b128 a[140:143], v8 offset:57344
    v_mfma_f32_16x16x32_bf16 v[190:193], a[96:99], a[72:75], v[190:193]
    ds_read_b128 a[144:147], v10 offset:8192
    s_add_u32 m0, s54, 90112
    v_mfma_f32_16x16x32_bf16 v[194:197], a[100:103], a[72:75], v[194:197]
    s_add_u32 s80, s78, 2048
    v_mfma_f32_16x16x32_bf16 v[198:201], a[104:107], a[72:75], v[198:201]
    buffer_load_dwordx4 v3, s[8:11], s80 offen lds
    v_mfma_f32_16x16x32_bf16 v[202:205], a[64:67], v[32:35], v[202:205]
    s_waitcnt vmcnt(12) lgkmcnt(5)
    s_barrier
    v_mfma_f32_16x16x32_bf16 v[206:209], a[124:127], a[124:127], v[206:209]
    ds_read_b64_tr_b16 a[64:65], v5 offset:24576
    s_add_u32 m0, s54, 94208
    v_mfma_f32_16x16x32_bf16 v[146:149], a[76:79], a[108:111], v[146:149]
    ds_read_b64_tr_b16 a[66:67], v5 offset:25088
    s_add_u32 s80, s78, 98304
    v_mfma_f32_16x16x32_bf16 v[150:153], a[76:79], a[112:115], v[150:153]
    buffer_load_dwordx4 v3, s[8:11], s80 offen lds
    s_cmp_eq_u32 s49, 6
    s_cbranch_scc1 Lt217
Lt2b18:
    v_mfma_f32_16x16x32_bf16 v[154:157], a[76:79], a[116:119], v[154:157]
    ds_read_b64_tr_b16 a[68:69], v5 offset:28672
    v_mfma_f32_16x16x32_bf16 v[158:161], a[76:79], a[120:123], v[158:161]
    ds_read_b64_tr_b16 a[70:71], v5 offset:29184
    v_mfma_f32_16x16x32_bf16 v[162:165], a[80:83], a[108:111], v[162:165]
    ds_read_b64_tr_b16 a[72:73], v5 offset:32768
    v_mfma_f32_16x16x32_bf16 v[166:169], a[80:83], a[112:115], v[166:169]
    ds_read_b64_tr_b16 a[74:75], v5 offset:33280
    s_add_u32 m0, s54, 98304
    v_mfma_f32_16x16x32_bf16 v[170:173], a[80:83], a[116:119], v[170:173]
    ds_read_b128 a[88:91], v9 offset:8192
    s_add_u32 s80, s78, 99328
    v_mfma_f32_16x16x32_bf16 v[174:177], a[80:83], a[120:123], v[174:177]
    buffer_load_dwordx4 v3, s[8:11], s80 offen lds
    v_mfma_f32_16x16x32_bf16 v[178:181], a[80:83], a[124:127], v[178:181]
    ds_read_b128 a[92:95], v9 offset:24576
    v_mfma_f32_16x16x32_bf16 v[182:185], a[108:111], a[84:87], v[182:185]
    ds_read_b128 a[96:99], v9 offset:40960
    v_mfma_f32_16x16x32_bf16 v[186:189], a[112:115], a[84:87], v[186:189]
    ds_read_b128 a[100:103], v9 offset:57344
    v_mfma_f32_16x16x32_bf16 v[190:193], a[116:119], a[84:87], v[190:193]
    ds_read_b128 a[104:107], v11 offset:8192
    s_add_u32 m0, s54, 102400
    v_mfma_f32_16x16x32_bf16 v[194:197], a[120:123], a[84:87], v[194:197]
    s_add_u32 s80, s78, 100352
    v_mfma_f32_16x16x32_bf16 v[198:201], a[124:127], a[84:87], v[198:201]
    buffer_load_dwordx4 v3, s[8:11], s80 offen lds
    v_mfma_f32_16x16x32_bf16 v[202:205], a[76:79], v[32:35], v[202:205]
    s_waitcnt vmcnt(12) lgkmcnt(5)
    s_barrier
    v_mfma_f32_16x16x32_bf16 v[206:209], a[144:147], a[144:147], v[206:209]
    ds_read_b64_tr_b16 a[76:77], v6 offset:0
    s_cmp_eq_u32 s49, 7
    s_cbranch_scc1 Lt219
Lt2b20:
    v_mfma_f32_16x16x32_bf16 v[146:149], a[64:67], a[128:131], v[146:149]
    ds_read_b64_tr_b16 a[78:79], v6 offset:512
    s_add_u32 m0, s54, 106496
    v_mfma_f32_16x16x32_bf16 v[150:153], a[64:67], a[132:135], v[150:153]
    buffer_load_dwordx4 v3, s[8:11], s79 offen lds
    v_mfma_f32_16x16x32_bf16 v[154:157], a[64:67], a[136:139], v[154:157]
    ds_read_b64_tr_b16 a[80:81], v6 offset:4096
    v_mfma_f32_16x16x32_bf16 v[158:161], a[64:67], a[140:143], v[158:161]
    ds_read_b64_tr_b16 a[82:83], v6 offset:4608
    v_mfma_f32_16x16x32_bf16 v[162:165], a[68:71], a[128:131], v[162:165]
    ds_read_b64_tr_b16 a[84:85], v6 offset:8192
    v_mfma_f32_16x16x32_bf16 v[166:169], a[68:71], a[132:135], v[166:169]
    ds_read_b64_tr_b16 a[86:87], v6 offset:8704
    s_add_u32 m0, s54, 110592
    v_mfma_f32_16x16x32_bf16 v[170:173], a[68:71], a[136:139], v[170:173]
    ds_read_b128 a[108:111], v8 offset:10240
    s_add_u32 s80, s79, 1024
    v_mfma_f32_16x16x32_bf16 v[174:177], a[68:71], a[140:143], v[174:177]
    buffer_load_dwordx4 v3, s[8:11], s80 offen lds
    v_mfma_f32_16x16x32_bf16 v[178:181], a[68:71], a[144:147], v[178:181]
    ds_read_b128 a[112:115], v8 offset:26624
    v_mfma_f32_16x16x32_bf16 v[182:185], a[128:131], a[72:75], v[182:185]
    ds_read_b128 a[116:119], v8 offset:43008
    v_mfma_f32_16x16x32_bf16 v[186:189], a[132:135], a[72:75], v[186:189]
    ds_read_b128 a[120:123], v8 offset:59392
    v_mfma_f32_16x16x32_bf16 v[190:193], a[136:139], a[72:75], v[190:193]
    ds_read_b128 a[124:127], v10 offset:10240
    s_add_u32 m0, s54, 114688
    v_mfma_f32_16x16x32_bf16 v[194:197], a[140:143], a[72:75], v[194:197]
    s_add_u32 s80, s79, 2048
    v_mfma_f32_16x16x32_bf16 v[198:201], a[144:147], a[72:75], v[198:201]
    buffer_load_dwordx4 v3, s[8:11], s80 offen lds
    v_mfma_f32_16x16x32_bf16 v[202:205], a[64:67], v[32:35], v[202:205]
    s_waitcnt vmcnt(12) lgkmcnt(5)
    s_barrier
    v_mfma_f32_16x16x32_bf16 v[206:209], a[104:107], a[104:107], v[206:209]
    ds_read_b64_tr_b16 a[64:65], v6 offset:12288
    v_mfma_f32_16x16x32_bf16 v[146:149], a[76:79], a[88:91], v[146:149]
    ds_read_b64_tr_b16 a[66:67], v6 offset:12800
    v_mfma_f32_16x16x32_bf16 v[150:153], a[76:79], a[92:95], v[150:153]
    s_cmp_lg_u32 s48, 3
    s_cbranch_scc1 Lpi21
    s_load_dword s69, s[36:37], s64 offset:132 glc
    s_load_dword s70, s[36:37], s65 offset:132 glc
    s_load_dword s71, s[36:37], s66 offset:132 glc
Lpi21:
    v_mfma_f32_16x16x32_bf16 v[154:157], a[76:79], a[96:99], v[154:157]
    ds_read_b64_tr_b16 a[68:69], v6 offset:16384
    v_mfma_f32_16x16x32_bf16 v[158:161], a[76:79], a[100:103], v[158:161]
    ds_read_b64_tr_b16 a[70:71], v6 offset:16896
    s_add_u32 m0, s54, 118784
    v_mfma_f32_16x16x32_bf16 v[162:165], a[80:83], a[88:91], v[162:165]
    ds_read_b64_tr_b16 a[72:73], v6 offset:20480
    s_add_u32 s80, s79, 98304
    v_mfma_f32_16x16x32_bf16 v[166:169], a[80:83], a[92:95], v[166:169]
    buffer_load_dwordx4 v3, s[8:11], s80 offen lds
    v_mfma_f32_16x16x32_bf16 v[170:173], a[80:83], a[96:99], v[170:173]
    ds_read_b64_tr_b16 a[74:75], v6 offset:20992
    v_mfma_f32_16x16x32_bf16 v[174:177], a[80:83], a[100:103], v[174:177]
    ds_read_b128 a[128:131], v9 offset:10240
    s_add_u32 m0, s54, 122880
    v_mfma_f32_16x16x32_bf16 v[178:181], a[80:83], a[104:107], v[178:181]
    ds_read_b128 a[132:135], v9 offset:26624
    s_add_u32 s80, s79, 99328
    v_mfma_f32_16x16x32_bf16 v[182:185], a[88:91], a[84:87], v[182:185]
    buffer_load_dwordx4 v3, s[8:11], s80 offen lds
    v_mfma_f32_16x16x32_bf16 v[186:189], a[92:95], a[84:87], v[186:189]
    ds_read_b128 a[136:139], v9 offset:43008
    v_mfma_f32_16x16x32_bf16 v[190:193], a[96:99], a[84:87], v[190:193]
    ds_read_b128 a[140:143], v9 offset:59392
    s_add_u32 m0, s54, 126976
    v_mfma_f32_16x16x32_bf16 v[194:197], a[100:103], a[84:87], v[194:197]
    ds_read_b128 a[144:147], v11 offset:10240
    s_add_u32 s80, s79, 100352
    v_mfma_f32_16x16x32_bf16 v[198:201], a[104:107], a[84:87], v[198:201]
    buffer_load_dwordx4 v3, s[8:11], s80 offen lds
    v_mfma_f32_16x16x32_bf16 v[202:205], a[76:79], v[32:35], v[202:205]
    s_waitcnt vmcnt(12) lgkmcnt(5)
    s_barrier
    v_mfma_f32_16x16x32_bf16 v[206:209], a[124:127], a[124:127], v[206:209]
    ds_read_b64_tr_b16 a[76:77], v6 offset:24576
    s_add_u32 m0, s54, 131072
    v_mfma_f32_16x16x32_bf16 v[146:149], a[64:67], a[108:111], v[146:149]
    ds_read_b64_tr_b16 a[78:79], v6 offset:25088
    s_mov_b32 s80, 0
    s_nop 0
    v_mfma_f32_16x16x32_bf16 v[150:153], a[64:67], a[112:115], v[150:153]
    buffer_load_dwordx4 v2, s[20:23], s80 offen lds
    v_mfma_f32_16x16x32_bf16 v[154:157], a[64:67], a[116:119], v[154:157]
    ds_read_b64_tr_b16 a[80:81], v6 offset:28672
    v_mfma_f32_16x16x32_bf16 v[158:161], a[64:67], a[120:123], v[158:161]
    ds_read_b64_tr_b16 a[82:83], v6 offset:29184
    v_mfma_f32_16x16x32_bf16 v[162:165], a[68:71], a[108:111], v[162:165]
    ds_read_b64_tr_b16 a[84:85], v6 offset:32768
    v_mfma_f32_16x16x32_bf16 v[166:169], a[68:71], a[112:115], v[166:169]
    ds_read_b64_tr_b16 a[86:87], v6 offset:33280
    s_add_u32 m0, s54, 135168
    v_mfma_f32_16x16x32_bf16 v[170:173], a[68:71], a[116:119], v[170:173]
    ds_read_b128 a[88:91], v8 offset:12288
    s_mov_b32 s80, 32768
    v_mfma_f32_16x16x32_bf16 v[174:177], a[68:71], a[120:123], v[174:177]
    buffer_load_dwordx4 v2, s[20:23], s80 offen lds
    v_mfma_f32_16x16x32_bf16 v[178:181], a[68:71], a[124:127], v[178:181]
    ds_read_b128 a[92:95], v8 offset:28672
    v_mfma_f32_16x16x32_bf16 v[182:185], a[108:111], a[72:75], v[182:185]
    ds_read_b128 a[96:99], v8 offset:45056
    v_mfma_f32_16x16x32_bf16 v[186:189], a[112:115], a[72:75], v[186:189]
    ds_read_b128 a[100:103], v8 offset:61440
    v_mfma_f32_16x16x32_bf16 v[190:193], a[116:119], a[72:75], v[190:193]
    ds_read_b128 a[104:107], v10 offset:12288
    s_add_u32 m0, s54, 139264
    v_mfma_f32_16x16x32_bf16 v[194:197], a[120:123], a[72:75], v[194:197]
    s_mov_b32 s80, 65536
    v_mfma_f32_16x16x32_bf16 v[198:201], a[124:127], a[72:75], v[198:201]
    buffer_load_dwordx4 v2, s[20:23], s80 offen lds
    v_mfma_f32_16x16x32_bf16 v[202:205], a[64:67], v[32:35], v[202:205]
    s_cmp_lg_u32 s48, 3
    s_cbranch_scc1 Lpolld23
    s_waitcnt lgkmcnt(0)
    s_min_u32 s69, s69, s70
    s_min_u32 s69, s69, s71
    s_cmp_lt_u32 s69, 8
    s_cbranch_scc1 Lpoll22
Lpolld23:
    s_waitcnt vmcnt(12) lgkmcnt(5)
    s_barrier
    s_nop 0
    v_mfma_f32_16x16x32_bf16 v[206:209], a[144:147], a[144:147], v[206:209]
    ds_read_b64_tr_b16 a[64:65], v5 offset:0
    s_add_u32 m0, s54, 143360
    v_mfma_f32_16x16x32_bf16 v[146:149], a[76:79], a[128:131], v[146:149]
    ds_read_b64_tr_b16 a[66:67], v5 offset:512
    s_mov_b32 s80, 98304
    v_mfma_f32_16x16x32_bf16 v[150:153], a[76:79], a[132:135], v[150:153]
    buffer_load_dwordx4 v2, s[20:23], s80 offen lds
    v_mfma_f32_16x16x32_bf16 v[154:157], a[76:79], a[136:139], v[154:157]
    ds_read_b64_tr_b16 a[68:69], v5 offset:4096
    v_mfma_f32_16x16x32_bf16 v[158:161], a[76:79], a[140:143], v[158:161]
    ds_read_b64_tr_b16 a[70:71], v5 offset:4608
    s_add_u32 m0, s54, 147456
    v_mfma_f32_16x16x32_bf16 v[162:165], a[80:83], a[128:131], v[162:165]
    ds_read_b64_tr_b16 a[72:73], v5 offset:8192
    s_mov_b32 s80, 131072
    v_mfma_f32_16x16x32_bf16 v[166:169], a[80:83], a[132:135], v[166:169]
    buffer_load_dwordx4 v2, s[20:23], s80 offen lds
    v_mfma_f32_16x16x32_bf16 v[170:173], a[80:83], a[136:139], v[170:173]
    ds_read_b64_tr_b16 a[74:75], v5 offset:8704
    v_mfma_f32_16x16x32_bf16 v[174:177], a[80:83], a[140:143], v[174:177]
    ds_read_b128 a[108:111], v9 offset:12288
    s_add_u32 m0, s54, 151552
    v_mfma_f32_16x16x32_bf16 v[178:181], a[80:83], a[144:147], v[178:181]
    ds_read_b128 a[112:115], v9 offset:28672
    s_mov_b32 s80, 163840
    v_mfma_f32_16x16x32_bf16 v[182:185], a[128:131], a[84:87], v[182:185]
    buffer_load_dwordx4 v2, s[20:23], s80 offen lds
    v_mfma_f32_16x16x32_bf16 v[186:189], a[132:135], a[84:87], v[186:189]
    ds_read_b128 a[116:119], v9 offset:45056
    v_mfma_f32_16x16x32_bf16 v[190:193], a[136:139], a[84:87], v[190:193]
    ds_read_b128 a[120:123], v9 offset:61440
    v_mfma_f32_16x16x32_bf16 v[194:197], a[140:143], a[84:87], v[194:197]
    ds_read_b128 a[124:127], v11 offset:12288
    s_mov_b32 s98, 0
    s_nop 0
    v_mfma_f32_16x16x32_bf16 v[198:201], a[144:147], a[84:87], v[198:201]
    buffer_load_dwordx4 a[0:3], v14, s[36:39], s98 offen offset:0 sc1
    v_mfma_f32_16x16x32_bf16 v[202:205], a[76:79], v[32:35], v[202:205]
    s_waitcnt vmcnt(13) lgkmcnt(5)
    s_barrier
    v_mfma_f32_16x16x32_bf16 v[206:209], a[104:107], a[104:107], v[206:209]
    ds_read_b64_tr_b16 a[76:77], v5 offset:12288
    s_add_u32 m0, s54, 81920
    v_mfma_f32_16x16x32_bf16 v[146:149], a[64:67], a[88:91], v[146:149]
    ds_read_b64_tr_b16 a[78:79], v5 offset:12800
    s_mov_b32 s80, 196608
    v_mfma_f32_16x16x32_bf16 v[150:153], a[64:67], a[92:95], v[150:153]
    buffer_load_dwordx4 v2, s[20:23], s80 offen lds
    v_mfma_f32_16x16x32_bf16 v[154:157], a[64:67], a[96:99], v[154:157]
    ds_read_b64_tr_b16 a[80:81], v5 offset:16384
    v_mfma_f32_16x16x32_bf16 v[158:161], a[64:67], a[100:103], v[158:161]
    ds_read_b64_tr_b16 a[82:83], v5 offset:16896
    s_add_u32 m0, s54, 86016
    v_mfma_f32_16x16x32_bf16 v[162:165], a[68:71], a[88:91], v[162:165]
    ds_read_b64_tr_b16 a[84:85], v5 offset:20480
    s_mov_b32 s80, 229376
    v_mfma_f32_16x16x32_bf16 v[166:169], a[68:71], a[92:95], v[166:169]
    buffer_load_dwordx4 v2, s[20:23], s80 offen lds
    v_mfma_f32_16x16x32_bf16 v[170:173], a[68:71], a[96:99], v[170:173]
    ds_read_b64_tr_b16 a[86:87], v5 offset:20992
    v_mfma_f32_16x16x32_bf16 v[174:177], a[68:71], a[100:103], v[174:177]
    ds_read_b128 a[128:131], v8 offset:14336
    s_add_u32 m0, s54, 90112
    v_mfma_f32_16x16x32_bf16 v[178:181], a[68:71], a[104:107], v[178:181]
    ds_read_b128 a[132:135], v8 offset:30720
    s_mov_b32 s80, 262144
    v_mfma_f32_16x16x32_bf16 v[182:185], a[88:91], a[72:75], v[182:185]
    buffer_load_dwordx4 v2, s[20:23], s80 offen lds
    v_mfma_f32_16x16x32_bf16 v[186:189], a[92:95], a[72:75], v[186:189]
    ds_read_b128 a[136:139], v8 offset:47104
    v_mfma_f32_16x16x32_bf16 v[190:193], a[96:99], a[72:75], v[190:193]
    ds_read_b128 a[140:143], v8 offset:63488
    v_mfma_f32_16x16x32_bf16 v[194:197], a[100:103], a[72:75], v[194:197]
    ds_read_b128 a[144:147], v10 offset:14336
    v_mfma_f32_16x16x32_bf16 v[198:201], a[104:107], a[72:75], v[198:201]
    buffer_load_dwordx4 a[4:7], v14, s[36:39], s98 offen offset:2048 sc1
    v_mfma_f32_16x16x32_bf16 v[202:205], a[64:67], v[32:35], v[202:205]
    s_waitcnt vmcnt(14) lgkmcnt(5)
    s_barrier
    v_mfma_f32_16x16x32_bf16 v[206:209], a[124:127], a[124:127], v[206:209]
    ds_read_b64_tr_b16 a[64:65], v5 offset:24576
    s_add_u32 m0, s54, 94208
    v_mfma_f32_16x16x32_bf16 v[146:149], a[76:79], a[108:111], v[146:149]
    ds_read_b64_tr_b16 a[66:67], v5 offset:25088
    s_mov_b32 s80, 294912
    v_mfma_f32_16x16x32_bf16 v[150:153], a[76:79], a[112:115], v[150:153]
    buffer_load_dwordx4 v2, s[20:23], s80 offen lds
    v_mfma_f32_16x16x32_bf16 v[154:157], a[76:79], a[116:119], v[154:157]
    ds_read_b64_tr_b16 a[68:69], v5 offset:28672
    s_add_u32 m0, s54, 98304
    v_mfma_f32_16x16x32_bf16 v[158:161], a[76:79], a[120:123], v[158:161]
    ds_read_b64_tr_b16 a[70:71], v5 offset:29184
    s_mov_b32 s80, 327680
    v_mfma_f32_16x16x32_bf16 v[162:165], a[80:83], a[108:111], v[162:165]
    buffer_load_dwordx4 v2, s[20:23], s80 offen lds
    v_mfma_f32_16x16x32_bf16 v[166:169], a[80:83], a[112:115], v[166:169]
    ds_read_b64_tr_b16 a[72:73], v5 offset:32768
    s_add_u32 m0, s54, 102400
    v_mfma_f32_16x16x32_bf16 v[170:173], a[80:83], a[116:119], v[170:173]
    ds_read_b64_tr_b16 a[74:75], v5 offset:33280
    s_mov_b32 s80, 360448
    v_mfma_f32_16x16x32_bf16 v[174:177], a[80:83], a[120:123], v[174:177]
    buffer_load_dwordx4 v2, s[20:23], s80 offen lds
    v_mfma_f32_16x16x32_bf16 v[178:181], a[80:83], a[124:127], v[178:181]
    ds_read_b128 a[88:91], v9 offset:14336
    v_mfma_f32_16x16x32_bf16 v[182:185], a[108:111], a[84:87], v[182:185]
    ds_read_b128 a[92:95], v9 offset:30720
    s_mov_b32 s98, 4096
    v_mfma_f32_16x16x32_bf16 v[186:189], a[112:115], a[84:87], v[186:189]
    buffer_load_dwordx4 a[8:11], v14, s[36:39], s98 offen offset:0 sc1
    v_mfma_f32_16x16x32_bf16 v[190:193], a[116:119], a[84:87], v[190:193]
    ds_read_b128 a[96:99], v9 offset:47104
    v_mfma_f32_16x16x32_bf16 v[194:197], a[120:123], a[84:87], v[194:197]
    ds_read_b128 a[100:103], v9 offset:63488
    v_mfma_f32_16x16x32_bf16 v[198:201], a[124:127], a[84:87], v[198:201]
    buffer_load_dwordx4 a[12:15], v14, s[36:39], s98 offen offset:2048 sc1
    v_mfma_f32_16x16x32_bf16 v[202:205], a[76:79], v[32:35], v[202:205]
    ds_read_b128 a[104:107], v11 offset:14336
    s_waitcnt vmcnt(16) lgkmcnt(5)
    s_barrier
    v_mfma_f32_16x16x32_bf16 v[206:209], a[144:147], a[144:147], v[206:209]
    ds_read_b64_tr_b16 a[76:77], v6 offset:0
    s_add_u32 m0, s54, 106496
    v_mfma_f32_16x16x32_bf16 v[146:149], a[64:67], a[128:131], v[146:149]
    ds_read_b64_tr_b16 a[78:79], v6 offset:512
    s_mov_b32 s80, 393216
    v_mfma_f32_16x16x32_bf16 v[150:153], a[64:67], a[132:135], v[150:153]
    buffer_load_dwordx4 v2, s[20:23], s80 offen lds
    v_mfma_f32_16x16x32_bf16 v[154:157], a[64:67], a[136:139], v[154:157]
    ds_read_b64_tr_b16 a[80:81], v6 offset:4096
    s_add_u32 m0, s54, 110592
    v_mfma_f32_16x16x32_bf16 v[158:161], a[64:67], a[140:143], v[158:161]
    ds_read_b64_tr_b16 a[82:83], v6 offset:4608
    s_mov_b32 s80, 425984
    v_mfma_f32_16x16x32_bf16 v[162:165], a[68:71], a[128:131], v[162:165]
    buffer_load_dwordx4 v2, s[20:23], s80 offen lds
    v_mfma_f32_16x16x32_bf16 v[166:169], a[68:71], a[132:135], v[166:169]
    ds_read_b64_tr_b16 a[84:85], v6 offset:8192
    s_add_u32 m0, s54, 114688
    v_mfma_f32_16x16x32_bf16 v[170:173], a[68:71], a[136:139], v[170:173]
    ds_read_b64_tr_b16 a[86:87], v6 offset:8704
    s_mov_b32 s80, 458752
    v_mfma_f32_16x16x32_bf16 v[174:177], a[68:71], a[140:143], v[174:177]
    buffer_load_dwordx4 v2, s[20:23], s80 offen lds
    v_mfma_f32_16x16x32_bf16 v[178:181], a[68:71], a[144:147], v[178:181]
    v_mfma_f32_16x16x32_bf16 v[182:185], a[128:131], a[72:75], v[182:185]
    s_mov_b32 s98, 8192
    v_mfma_f32_16x16x32_bf16 v[186:189], a[132:135], a[72:75], v[186:189]
    buffer_load_dwordx4 a[16:19], v15, s[36:39], s98 offen offset:0 sc1
    v_mfma_f32_16x16x32_bf16 v[190:193], a[136:139], a[72:75], v[190:193]
    v_mfma_f32_16x16x32_bf16 v[194:197], a[140:143], a[72:75], v[194:197]
    v_mfma_f32_16x16x32_bf16 v[198:201], a[144:147], a[72:75], v[198:201]
    buffer_load_dwordx4 a[20:23], v15, s[36:39], s98 offen offset:2048 sc1
    v_mfma_f32_16x16x32_bf16 v[202:205], a[64:67], v[32:35], v[202:205]
    s_waitcnt vmcnt(9) lgkmcnt(0)
    s_barrier
    v_mfma_f32_16x16x32_bf16 v[206:209], a[104:107], a[104:107], v[206:209]
    ds_read_b64_tr_b16 a[192:193], v94 offset:8192
    ds_read_b64_tr_b16 a[194:195], v94 offset:8704
    s_add_u32 m0, s54, 118784
    v_mfma_f32_16x16x32_bf16 v[146:149], a[76:79], a[88:91], v[146:149]
    ds_read_b64_tr_b16 a[196:197], v95 offset:8192
    s_mov_b32 s80, 491520
    v_mfma_f32_16x16x32_bf16 v[150:153], a[76:79], a[92:95], v[150:153]
    buffer_load_dwordx4 v2, s[20:23], s80 offen lds
    v_mfma_f32_16x16x32_bf16 v[154:157], a[76:79], a[96:99], v[154:157]
    ds_read_b64_tr_b16 a[198:199], v95 offset:8704
    v_mfma_f32_16x16x32_bf16 v[158:161], a[76:79], a[100:103], v[158:161]
    ds_read_b64_tr_b16 a[200:201], v94 offset:12288
    s_mov_b32 s98, 12288
    v_mfma_f32_16x16x32_bf16 v[162:165], a[80:83], a[88:91], v[162:165]
    buffer_load_dwordx4 a[24:27], v15, s[36:39], s98 offen offset:0 sc1
    v_mfma_f32_16x16x32_bf16 v[166:169], a[80:83], a[92:95], v[166:169]
    ds_read_b64_tr_b16 a[202:203], v94 offset:12800
    v_mfma_f32_16x16x32_bf16 v[170:173], a[80:83], a[96:99], v[170:173]
    ds_read_b64_tr_b16 a[204:205], v95 offset:12288
    v_mfma_f32_16x16x32_bf16 v[174:177], a[80:83], a[100:103], v[174:177]
    buffer_load_dwordx4 a[28:31], v15, s[36:39], s98 offen offset:2048 sc1
    v_mfma_f32_16x16x32_bf16 v[178:181], a[80:83], a[104:107], v[178:181]
    ds_read_b64_tr_b16 a[206:207], v95 offset:12800
    v_mfma_f32_16x16x32_bf16 v[182:185], a[88:91], a[84:87], v[182:185]
    ds_read_b64_tr_b16 a[208:209], v94 offset:16384
    s_mov_b32 s98, 16384
    v_mfma_f32_16x16x32_bf16 v[186:189], a[92:95], a[84:87], v[186:189]
    buffer_load_dwordx4 a[32:35], v16, s[36:39], s98 offen offset:0 sc1
    v_mfma_f32_16x16x32_bf16 v[190:193], a[96:99], a[84:87], v[190:193]
    ds_read_b64_tr_b16 a[210:211], v94 offset:16896
    v_mfma_f32_16x16x32_bf16 v[194:197], a[100:103], a[84:87], v[194:197]
    ds_read_b64_tr_b16 a[212:213], v95 offset:16384
    v_mfma_f32_16x16x32_bf16 v[198:201], a[104:107], a[84:87], v[198:201]
    buffer_load_dwordx4 a[36:39], v16, s[36:39], s98 offen offset:2048 sc1
    v_mfma_f32_16x16x32_bf16 v[202:205], a[76:79], v[32:35], v[202:205]
    ds_read_b64_tr_b16 a[214:215], v95 offset:16896
    s_waitcnt lgkmcnt(8)
    s_nop 0
    v_mfma_f32_32x32x16_bf16 v[70:85], a[196:199], a[0:3], 0
    ds_read_b64_tr_b16 a[216:217], v94 offset:20480
    ds_read_b64_tr_b16 a[218:219], v94 offset:20992
    v_mov_b32 v214, v206
    v_mov_b32 v215, v206
    s_nop 1
    v_permlane16_swap_b32 v214, v215
    s_mov_b32 s98, 20480
    v_mfma_f32_32x32x16_bf16 v[54:69], a[192:195], a[0:3], 0
    ds_read_b64_tr_b16 a[220:221], v95 offset:20480
    ds_read_b64_tr_b16 a[222:223], v95 offset:20992
    v_mov_b32 v215, v214
    s_nop 1
    v_permlane32_swap_b32 v214, v215
    v_cndmask_b32 v210, v206, v207, s[84:85]
    buffer_load_dwordx4 a[40:43], v16, s[36:39], s98 offen offset:0 sc1
    s_waitcnt lgkmcnt(8)
    v_mfma_f32_32x32x16_bf16 v[70:85], a[204:207], a[4:7], v[70:85]
    ds_read_b64_tr_b16 a[192:193], v94 offset:24576
    ds_read_b64_tr_b16 a[194:195], v94 offset:25088
    v_cndmask_b32 v210, v210, v208, s[86:87]
    v_cndmask_b32 v210, v210, v209, s[88:89]
    v_mul_f32 v211, 0x3b000000, v214
    v_mfma_f32_32x32x16_bf16 v[54:69], a[200:203], a[4:7], v[54:69]
    ds_read_b64_tr_b16 a[196:197], v95 offset:24576
    ds_read_b64_tr_b16 a[198:199], v95 offset:25088
    v_mul_f32 v210, 0x3b000000, v210
    v_fma_f32 v212, -v211, v211, v210
    v_max_f32_e64 v212, 0, v212
    buffer_load_dwordx4 a[44:47], v16, s[36:39], s98 offen offset:2048 sc1
    s_waitcnt vmcnt(13) lgkmcnt(8)
    s_nop 0
    v_mfma_f32_32x32x16_bf16 v[70:85], a[212:215], a[8:11], v[70:85]
    ds_read_b64_tr_b16 a[200:201], v94 offset:28672
    ds_read_b64_tr_b16 a[202:203], v94 offset:29184
    v_add_f32 v213, 0x3727c5ac, v212
    v_rsq_f32_e64 v213, v213
    s_mov_b32 s98, 24576
    v_mfma_f32_32x32x16_bf16 v[54:69], a[208:211], a[8:11], v[54:69]
    ds_read_b64_tr_b16 a[204:205], v95 offset:28672
    ds_read_b64_tr_b16 a[206:207], v95 offset:29184
    s_mov_b64 exec, s[90:91]
    ds_write_b32 v101, v211 offset:256
    ds_write_b32 v101, v213 offset:576
    s_mov_b64 exec, -1
    v_mul_f32 v44, v44, v45
    v_lshlrev_b32 v226, 16, v46
    buffer_load_dwordx4 a[48:51], v17, s[36:39], s98 offen offset:0 sc1
    s_waitcnt vmcnt(13) lgkmcnt(10)
    s_nop 0
    v_mfma_f32_32x32x16_bf16 v[70:85], a[220:223], a[12:15], v[70:85]
    ds_read_b64_tr_b16 a[208:209], v92 offset:20480
    ds_read_b64_tr_b16 a[210:211], v92 offset:20992
    v_and_b32 v227, 0xffff0000, v46
    v_lshlrev_b32_e64 v228, 16, v47
    v_and_b32 v229, 0xffff0000, v47
    v_mfma_f32_32x32x16_bf16 v[54:69], a[216:219], a[12:15], v[54:69]
    ds_read_b64_tr_b16 a[212:213], v93 offset:20480
    ds_read_b64_tr_b16 a[214:215], v93 offset:20992
    v_lshlrev_b32_e64 v230, 16, v48
    v_and_b32 v231, 0xffff0000, v48
    v_lshlrev_b32_e64 v232, 16, v49
    buffer_load_dwordx4 a[52:55], v17, s[36:39], s98 offen offset:2048 sc1
    s_waitcnt vmcnt(10) lgkmcnt(10)
    s_nop 0
    v_mfma_f32_32x32x16_bf16 v[70:85], a[196:199], a[16:19], v[70:85]
    ds_read_b64_tr_b16 a[216:217], v92 offset:24576
    ds_read_b64_tr_b16 a[218:219], v92 offset:25088
    v_and_b32 v233, 0xffff0000, v49
    v_lshlrev_b32_e64 v234, 16, v50
    v_and_b32 v235, 0xffff0000, v50
    s_mov_b32 s98, 28672
    v_mfma_f32_32x32x16_bf16 v[54:69], a[192:195], a[16:19], v[54:69]
    ds_read_b64_tr_b16 a[220:221], v93 offset:24576
    ds_read_b64_tr_b16 a[222:223], v93 offset:25088
    v_lshlrev_b32_e64 v236, 16, v51
    v_and_b32 v237, 0xffff0000, v51
    v_lshlrev_b32 v238, 16, v52
    s_waitcnt vmcnt(9) lgkmcnt(10)
    v_mfma_f32_32x32x16_bf16 v[70:85], a[204:207], a[20:23], v[70:85]
    ds_read_b64_tr_b16 a[192:193], v92 offset:28672
    ds_read_b64_tr_b16 a[194:195], v92 offset:29184
    v_and_b32 v239, 0xffff0000, v52
    v_lshlrev_b32_e64 v240, 16, v53
    v_and_b32 v241, 0xffff0000, v53
    buffer_load_dwordx4 a[56:59], v17, s[36:39], s98 offen offset:0 sc1
    v_mfma_f32_32x32x16_bf16 v[54:69], a[200:203], a[20:23], v[54:69]
    ds_read_b64_tr_b16 a[196:197], v93 offset:28672
    ds_read_b64_tr_b16 a[198:199], v93 offset:29184
    s_waitcnt vmcnt(8) lgkmcnt(8)
    s_nop 0
    v_mfma_f32_32x32x16_bf16 v[70:85], a[212:215], a[24:27], v[70:85]
    ds_read_b64_tr_b16 a[200:201], v92 offset:32768
    ds_read_b64_tr_b16 a[202:203], v92 offset:33280
    buffer_load_dwordx4 a[60:63], v17, s[36:39], s98 offen offset:2048 sc1
    v_mfma_f32_32x32x16_bf16 v[54:69], a[208:211], a[24:27], v[54:69]
    ds_read_b64_tr_b16 a[204:205], v93 offset:32768
    ds_read_b64_tr_b16 a[206:207], v93 offset:33280
    s_bfm_b64 exec, 11, 0
    buffer_load_dword v13, v12, s[44:47], s3 offen
    s_mov_b64 exec, -1
    s_barrier
    s_waitcnt vmcnt(9) lgkmcnt(8)
    v_mfma_f32_32x32x16_bf16 v[70:85], a[220:223], a[28:31], v[70:85]
    ds_read_b64_tr_b16 a[208:209], v92 offset:36864
    ds_read_b64_tr_b16 a[210:211], v92 offset:37376
    s_add_u32 m0, s54, 0
    s_nop 0
    v_mfma_f32_32x32x16_bf16 v[54:69], a[216:219], a[28:31], v[54:69]
    ds_read_b64_tr_b16 a[212:213], v93 offset:36864
    ds_read_b64_tr_b16 a[214:215], v93 offset:37376
    buffer_load_dwordx4 v4, s[4:7], s56 offen lds
    s_waitcnt vmcnt(9) lgkmcnt(8)
    s_nop 0
    v_mfma_f32_32x32x16_bf16 v[70:85], a[196:199], a[32:35], v[70:85]
    ds_read_b64_tr_b16 a[216:217], v92 offset:40960
    ds_read_b64_tr_b16 a[218:219], v92 offset:41472
    s_add_u32 m0, s54, 4096
    s_add_u32 s56, s56, s16
    s_nop 0
    v_mfma_f32_32x32x16_bf16 v[54:69], a[192:195], a[32:35], v[54:69]
    ds_read_b64_tr_b16 a[220:221], v93 offset:40960
    ds_read_b64_tr_b16 a[222:223], v93 offset:41472
    buffer_load_dwordx4 v4, s[4:7], s56 offen lds
    s_waitcnt vmcnt(9) lgkmcnt(8)
    s_nop 0
    v_mfma_f32_32x32x16_bf16 v[70:85], a[204:207], a[36:39], v[70:85]
    ds_read_b64_tr_b16 a[192:193], v92 offset:45056
    ds_read_b64_tr_b16 a[194:195], v92 offset:45568
    s_add_u32 m0, s54, 8192
    v_mfma_f32_32x32x16_bf16 v[54:69], a[200:203], a[36:39], v[54:69]
    ds_read_b64_tr_b16 a[196:197], v93 offset:45056
    ds_read_b64_tr_b16 a[198:199], v93 offset:45568
    s_add_u32 s56, s56, s16
    buffer_load_dwordx4 v4, s[4:7], s56 offen lds
    s_waitcnt vmcnt(9) lgkmcnt(8)
    v_mfma_f32_32x32x16_bf16 v[70:85], a[212:215], a[40:43], v[70:85]
    ds_read_b64_tr_b16 a[200:201], v92 offset:49152
    ds_read_b64_tr_b16 a[202:203], v92 offset:49664
    s_add_u32 m0, s54, 12288
    v_mfma_f32_32x32x16_bf16 v[54:69], a[208:211], a[40:43], v[54:69]
    ds_read_b64_tr_b16 a[204:205], v93 offset:49152
    ds_read_b64_tr_b16 a[206:207], v93 offset:49664
    s_add_u32 s56, s56, s16
    s_waitcnt vmcnt(8) lgkmcnt(8)
    v_mfma_f32_32x32x16_bf16 v[70:85], a[220:223], a[44:47], v[70:85]
    ds_read_b64_tr_b16 a[208:209], v92 offset:53248
    ds_read_b64_tr_b16 a[210:211], v92 offset:53760
    buffer_load_dwordx4 v4, s[4:7], s56 offen lds
    s_add_u32 m0, s54, 16384
    v_mfma_f32_32x32x16_bf16 v[54:69], a[216:219], a[44:47], v[54:69]
    ds_read_b64_tr_b16 a[212:213], v93 offset:53248
    ds_read_b64_tr_b16 a[214:215], v93 offset:53760
    s_add_u32 s56, s56, s17
    s_waitcnt vmcnt(8) lgkmcnt(8)
    v_mfma_f32_32x32x16_bf16 v[70:85], a[196:199], a[48:51], v[70:85]
    ds_read_b64_tr_b16 a[216:217], v92 offset:57344
    ds_read_b64_tr_b16 a[218:219], v92 offset:57856
    buffer_load_dwordx4 v4, s[4:7], s56 offen lds
    v_mfma_f32_32x32x16_bf16 v[54:69], a[192:195], a[48:51], v[54:69]
    ds_read_b64_tr_b16 a[220:221], v93 offset:57344
    ds_read_b64_tr_b16 a[222:223], v93 offset:57856
    s_add_u32 m0, s54, 20480
    s_add_u32 s56, s56, s16
    s_waitcnt vmcnt(8) lgkmcnt(8)
    v_mfma_f32_32x32x16_bf16 v[70:85], a[204:207], a[52:55], v[70:85]
    buffer_load_dwordx4 v4, s[4:7], s56 offen lds
    s_waitcnt vmcnt(8) lgkmcnt(4)
    v_mfma_f32_32x32x16_bf16 v[70:85], a[212:215], a[56:59], v[70:85]
    s_add_u32 m0, s54, 24576
    s_waitcnt vmcnt(7) lgkmcnt(0)
    v_mfma_f32_32x32x16_bf16 v[70:85], a[220:223], a[60:63], v[70:85]
    s_add_u32 s56, s56, s16
    s_nop 0
    buffer_load_dwordx4 v4, s[4:7], s56 offen lds
    v_mfma_f32_32x32x16_bf16 v[54:69], a[200:203], a[52:55], v[54:69]
    s_add_u32 m0, s54, 28672
    v_mfma_f32_32x32x16_bf16 v[54:69], a[208:211], a[56:59], v[54:69]
    s_nop 6
    ds_write_b128 v104, v[70:73] offset:0
    ds_write_b128 v104, v[74:77] offset:1024
    s_add_u32 s56, s56, s16
    v_mfma_f32_32x32x16_bf16 v[54:69], a[216:219], a[60:63], v[54:69]
    ds_write_b128 v104, v[78:81] offset:2048
    ds_write_b128 v104, v[82:85] offset:3072
    buffer_load_dwordx4 v4, s[4:7], s56 offen lds
    s_add_u32 m0, s54, 32768
    v_pk_fma_f32 v[210:211], v[226:227], v[44:45], v[44:45] op_sel:[0,1,0] op_sel_hi:[1,1,0] neg_lo:[0,0,1] neg_hi:[0,0,1]
    v_pk_fma_f32 v[212:213], v[228:229], v[44:45], v[44:45] op_sel:[0,1,0] op_sel_hi:[1,1,0] neg_lo:[0,0,1] neg_hi:[0,0,1]
    v_pk_fma_f32 v[214:215], v[230:231], v[44:45], v[44:45] op_sel:[0,1,0] op_sel_hi:[1,1,0] neg_lo:[0,0,1] neg_hi:[0,0,1]
    v_pk_fma_f32 v[216:217], v[232:233], v[44:45], v[44:45] op_sel:[0,1,0] op_sel_hi:[1,1,0] neg_lo:[0,0,1] neg_hi:[0,0,1]
    v_pk_fma_f32 v[218:219], v[234:235], v[44:45], v[44:45] op_sel:[0,1,0] op_sel_hi:[1,1,0] neg_lo:[0,0,1] neg_hi:[0,0,1]
    v_pk_fma_f32 v[220:221], v[236:237], v[44:45], v[44:45] op_sel:[0,1,0] op_sel_hi:[1,1,0] neg_lo:[0,0,1] neg_hi:[0,0,1]
    v_pk_fma_f32 v[222:223], v[238:239], v[44:45], v[44:45] op_sel:[0,1,0] op_sel_hi:[1,1,0] neg_lo:[0,0,1] neg_hi:[0,0,1]
    v_pk_fma_f32 v[224:225], v[240:241], v[44:45], v[44:45] op_sel:[0,1,0] op_sel_hi:[1,1,0] neg_lo:[0,0,1] neg_hi:[0,0,1]
    v_pk_add_f32 v[54:55], v[54:55], v[210:211]
    v_pk_add_f32 v[56:57], v[56:57], v[212:213]
    v_pk_add_f32 v[58:59], v[58:59], v[214:215]
    v_pk_add_f32 v[60:61], v[60:61], v[216:217]
    v_pk_add_f32 v[62:63], v[62:63], v[218:219]
    v_pk_add_f32 v[64:65], v[64:65], v[220:221]
    v_pk_add_f32 v[66:67], v[66:67], v[222:223]
    v_pk_add_f32 v[68:69], v[68:69], v[224:225]
    s_waitcnt lgkmcnt(0)
    s_barrier
    ds_read_b128 v[210:213], v105 offset:0
    ds_read_b128 v[214:217], v105 offset:1024
    ds_read_b128 v[218:221], v105 offset:2048
    ds_read_b128 v[222:225], v105 offset:3072
    s_add_u32 s56, s56, s18
    buffer_load_dwordx4 v4, s[4:7], s56 offen lds
    s_add_u32 m0, s54, 36864
    s_add_u32 s56, s56, s16
    buffer_load_dwordx4 v4, s[4:7], s56 offen lds
    s_waitcnt lgkmcnt(3)
    s_nop 0
    v_pk_add_f32 v[70:71], v[54:55], v[210:211]
    v_cvt_pk_bf16_f32 v46, v70, v71
    v_pk_add_f32 v[72:73], v[56:57], v[212:213]
    v_cvt_pk_bf16_f32 v47, v72, v73
    s_waitcnt lgkmcnt(2)
    s_nop 0
    v_pk_add_f32 v[74:75], v[58:59], v[214:215]
    v_cvt_pk_bf16_f32 v48, v74, v75
    v_pk_add_f32 v[76:77], v[60:61], v[216:217]
    v_cvt_pk_bf16_f32 v49, v76, v77
    buffer_store_dwordx4 v[46:49], v27, s[36:39], 0 offen offset:0 sc1
    s_waitcnt lgkmcnt(1)
    s_nop 0
    v_pk_add_f32 v[78:79], v[62:63], v[218:219]
    v_cvt_pk_bf16_f32 v50, v78, v79
    v_pk_add_f32 v[80:81], v[64:65], v[220:221]
    v_cvt_pk_bf16_f32 v51, v80, v81
    s_waitcnt lgkmcnt(0)
    s_nop 0
    v_pk_add_f32 v[82:83], v[66:67], v[222:223]
    v_cvt_pk_bf16_f32 v52, v82, v83
    v_pk_add_f32 v[84:85], v[68:69], v[224:225]
    v_cvt_pk_bf16_f32 v53, v84, v85
    buffer_store_dwordx4 v[50:53], v27, s[36:39], 0 offen offset:512 sc1
    v_pk_add_f32 v[206:207], v[70:71], v[72:73]
    v_pk_mul_f32 v[208:209], v[70:71], v[70:71]
    v_pk_fma_f32 v[208:209], v[72:73], v[72:73], v[208:209]
    v_pk_add_f32 v[206:207], v[206:207], v[74:75]
    v_pk_fma_f32 v[208:209], v[74:75], v[74:75], v[208:209]
    v_pk_add_f32 v[206:207], v[206:207], v[76:77]
    v_pk_fma_f32 v[208:209], v[76:77], v[76:77], v[208:209]
    v_pk_add_f32 v[206:207], v[206:207], v[78:79]
    v_pk_fma_f32 v[208:209], v[78:79], v[78:79], v[208:209]
    v_pk_add_f32 v[206:207], v[206:207], v[80:81]
    v_pk_fma_f32 v[208:209], v[80:81], v[80:81], v[208:209]
    v_pk_add_f32 v[206:207], v[206:207], v[82:83]
    v_pk_fma_f32 v[208:209], v[82:83], v[82:83], v[208:209]
    v_pk_add_f32 v[206:207], v[206:207], v[84:85]
    v_pk_fma_f32 v[208:209], v[84:85], v[84:85], v[208:209]
    v_add_f32 v206, v206, v207
    v_add_f32 v208, v208, v209
    v_pk_add_f32 v[54:55], v[70:71], v[226:227]
    v_pk_add_f32 v[56:57], v[72:73], v[228:229]
    v_permlane32_swap_b32 v206, v208
    v_add_f32 v206, v206, v208
    buffer_store_dword v206, v28, s[36:39], 0 offen sc1
    v_pk_add_f32 v[58:59], v[74:75], v[230:231]
    v_pk_add_f32 v[60:61], v[76:77], v[232:233]
    v_pk_add_f32 v[62:63], v[78:79], v[234:235]
    v_pk_add_f32 v[64:65], v[80:81], v[236:237]
    v_pk_add_f32 v[66:67], v[82:83], v[238:239]
    v_pk_add_f32 v[68:69], v[84:85], v[240:241]
    v_add_u32 v104, 65536, v104
    v_add_u32 v105, 65536, v105
    ds_read2_b32 v[44:45], v101 offset0:0 offset1:80
    ds_read2_b32 v[46:47], v101 offset0:16 offset1:96
    ds_read2_b32 v[48:49], v101 offset0:32 offset1:112
    ds_read2_b32 v[50:51], v101 offset0:48 offset1:128
    ds_read2_b32 v[52:53], v101 offset0:64 offset1:144
    ds_read_b128 v[206:209], v102 offset:0
    ds_read_b128 v[226:229], v102 offset:320
    ds_read_b128 v[210:213], v102 offset:64
    ds_read_b128 v[230:233], v102 offset:384
    ds_read_b128 v[214:217], v102 offset:128
    ds_read_b128 v[234:237], v102 offset:448
    ds_read_b128 v[218:221], v102 offset:192
    ds_read_b128 v[238:241], v102 offset:512
    ds_read_b128 v[222:225], v102 offset:256
    ds_read_b128 v[242:245], v102 offset:576
    v_mov_b32_dpp v136, v178 row_newbcast:0 row_mask:0xf bank_mask:0xf
    s_add_u32 m0, s54, 40960
    v_mov_b32_dpp v137, v179 row_newbcast:0 row_mask:0xf bank_mask:0xf
    v_mov_b32_dpp v138, v180 row_newbcast:0 row_mask:0xf bank_mask:0xf
    s_add_u32 s56, s56, s16
    v_mov_b32_dpp v139, v181 row_newbcast:0 row_mask:0xf bank_mask:0xf
    v_mov_b32 v140, v198
    buffer_load_dwordx4 v4, s[4:7], s56 offen lds
    v_mov_b32 v141, v198
    s_nop 1
    v_permlane16_swap_b32 v140, v141
    s_add_u32 m0, s54, 45056
    v_mov_b32 v141, v140
    s_nop 1
    v_permlane32_swap_b32 v140, v141
    s_add_u32 s56, s56, s16
    s_waitcnt lgkmcnt(10)
    buffer_load_dwordx4 v4, s[4:7], s56 offen lds
    v_pk_fma_f32 v[162:163], v[136:137], v[44:45], v[162:163] op_sel:[0,0,0] op_sel_hi:[1,0,1] neg_lo:[0,1,0] neg_hi:[0,1,0]
    v_pk_fma_f32 v[164:165], v[138:139], v[44:45], v[164:165] op_sel:[0,0,0] op_sel_hi:[1,0,1] neg_lo:[0,1,0] neg_hi:[0,1,0]
    s_add_u32 m0, s54, 49152
    v_pk_mul_f32 v[162:163], v[162:163], v[44:45] op_sel:[0,1] op_sel_hi:[1,1]
    v_pk_mul_f32 v[164:165], v[164:165], v[44:45] op_sel:[0,1] op_sel_hi:[1,1]
    v_pk_fma_f32 v[166:167], v[136:137], v[46:47], v[166:167] op_sel:[0,0,0] op_sel_hi:[1,0,1] neg_lo:[0,1,0] neg_hi:[0,1,0]
    s_add_u32 s56, s56, s17
    s_nop 0
    v_pk_fma_f32 v[168:169], v[138:139], v[46:47], v[168:169] op_sel:[0,0,0] op_sel_hi:[1,0,1] neg_lo:[0,1,0] neg_hi:[0,1,0]
    v_pk_mul_f32 v[166:167], v[166:167], v[46:47] op_sel:[0,1] op_sel_hi:[1,1]
    buffer_load_dwordx4 v4, s[4:7], s56 offen lds
    v_pk_mul_f32 v[168:169], v[168:169], v[46:47] op_sel:[0,1] op_sel_hi:[1,1]
    v_pk_fma_f32 v[170:171], v[136:137], v[48:49], v[170:171] op_sel:[0,0,0] op_sel_hi:[1,0,1] neg_lo:[0,1,0] neg_hi:[0,1,0]
    s_add_u32 m0, s54, 53248
    v_pk_fma_f32 v[172:173], v[138:139], v[48:49], v[172:173] op_sel:[0,0,0] op_sel_hi:[1,0,1] neg_lo:[0,1,0] neg_hi:[0,1,0]
    v_pk_mul_f32 v[170:171], v[170:171], v[48:49] op_sel:[0,1] op_sel_hi:[1,1]
    v_pk_mul_f32 v[172:173], v[172:173], v[48:49] op_sel:[0,1] op_sel_hi:[1,1]
    s_add_u32 s56, s56, s16
    s_nop 0
    v_pk_fma_f32 v[174:175], v[136:137], v[50:51], v[174:175] op_sel:[0,0,0] op_sel_hi:[1,0,1] neg_lo:[0,1,0] neg_hi:[0,1,0]
    v_pk_fma_f32 v[176:177], v[138:139], v[50:51], v[176:177] op_sel:[0,0,0] op_sel_hi:[1,0,1] neg_lo:[0,1,0] neg_hi:[0,1,0]
    buffer_load_dwordx4 v4, s[4:7], s56 offen lds
    v_pk_mul_f32 v[174:175], v[174:175], v[50:51] op_sel:[0,1] op_sel_hi:[1,1]
    v_pk_mul_f32 v[176:177], v[176:177], v[50:51] op_sel:[0,1] op_sel_hi:[1,1]
    s_add_u32 m0, s54, 57344
    v_pk_fma_f32 v[178:179], v[136:137], v[52:53], v[178:179] op_sel:[0,0,0] op_sel_hi:[1,0,1] neg_lo:[0,1,0] neg_hi:[0,1,0]
    v_pk_fma_f32 v[180:181], v[138:139], v[52:53], v[180:181] op_sel:[0,0,0] op_sel_hi:[1,0,1] neg_lo:[0,1,0] neg_hi:[0,1,0]
    v_pk_mul_f32 v[178:179], v[178:179], v[52:53] op_sel:[0,1] op_sel_hi:[1,1]
    s_add_u32 s56, s56, s16
    s_nop 0
    v_pk_mul_f32 v[180:181], v[180:181], v[52:53] op_sel:[0,1] op_sel_hi:[1,1]
    v_mul_f32 v45, 0x3eb8aa3b, v45
    buffer_load_dwordx4 v4, s[4:7], s56 offen lds
    v_mul_f32 v47, 0x3eb8aa3b, v47
    v_mul_f32 v49, 0x3eb8aa3b, v49
    s_add_u32 m0, s54, 61440
    v_mul_f32 v51, 0x3eb8aa3b, v51
    v_pk_fma_f32 v[146:147], v[202:203], v[44:45], v[146:147] op_sel:[0,0,0] op_sel_hi:[1,0,1] neg_lo:[0,1,0] neg_hi:[0,1,0]
    v_pk_fma_f32 v[148:149], v[204:205], v[44:45], v[148:149] op_sel:[0,0,0] op_sel_hi:[1,0,1] neg_lo:[0,1,0] neg_hi:[0,1,0]
    s_add_u32 s56, s56, s16
    s_nop 0
    v_pk_mul_f32 v[146:147], v[146:147], v[44:45] op_sel:[0,1] op_sel_hi:[1,1]
    v_pk_mul_f32 v[148:149], v[148:149], v[44:45] op_sel:[0,1] op_sel_hi:[1,1]
    buffer_load_dwordx4 v4, s[4:7], s56 offen lds
    v_pk_fma_f32 v[150:151], v[202:203], v[46:47], v[150:151] op_sel:[0,0,0] op_sel_hi:[1,0,1] neg_lo:[0,1,0] neg_hi:[0,1,0]
    v_pk_fma_f32 v[152:153], v[204:205], v[46:47], v[152:153] op_sel:[0,0,0] op_sel_hi:[1,0,1] neg_lo:[0,1,0] neg_hi:[0,1,0]
    s_add_u32 m0, s54, 81920
    v_pk_mul_f32 v[150:151], v[150:151], v[46:47] op_sel:[0,1] op_sel_hi:[1,1]
    v_pk_mul_f32 v[152:153], v[152:153], v[46:47] op_sel:[0,1] op_sel_hi:[1,1]
    v_pk_fma_f32 v[154:155], v[202:203], v[48:49], v[154:155] op_sel:[0,0,0] op_sel_hi:[1,0,1] neg_lo:[0,1,0] neg_hi:[0,1,0]
    s_add_u32 s56, s56, s19
    s_nop 0
    v_pk_fma_f32 v[156:157], v[204:205], v[48:49], v[156:157] op_sel:[0,0,0] op_sel_hi:[1,0,1] neg_lo:[0,1,0] neg_hi:[0,1,0]
    v_pk_mul_f32 v[154:155], v[154:155], v[48:49] op_sel:[0,1] op_sel_hi:[1,1]
    buffer_load_dwordx4 v4, s[4:7], s56 offen lds
    v_pk_mul_f32 v[156:157], v[156:157], v[48:49] op_sel:[0,1] op_sel_hi:[1,1]
    v_pk_fma_f32 v[158:159], v[202:203], v[50:51], v[158:159] op_sel:[0,0,0] op_sel_hi:[1,0,1] neg_lo:[0,1,0] neg_hi:[0,1,0]
    s_add_u32 m0, s54, 86016
    v_pk_fma_f32 v[160:161], v[204:205], v[50:51], v[160:161] op_sel:[0,0,0] op_sel_hi:[1,0,1] neg_lo:[0,1,0] neg_hi:[0,1,0]
    v_pk_mul_f32 v[158:159], v[158:159], v[50:51] op_sel:[0,1] op_sel_hi:[1,1]
    s_waitcnt vmcnt(7)
    s_barrier
    s_cmp_lg_u32 s48, 0
    s_cbranch_scc1 Lsg24
    s_atomic_add s1, s[36:37], s68 offset:260
Lsg24:
    s_lshr_b32 s81, s53, 4
    v_subrev_u32 v14, s81, v21
    v_pk_mul_f32 v[160:161], v[160:161], v[50:51] op_sel:[0,1] op_sel_hi:[1,1]
    s_add_u32 s56, s56, s16
    s_nop 0
    v_cvt_pk_bf16_f32 v70, v146, v147
    v_cvt_pk_bf16_f32 v71, v148, v149
    v_cvt_pk_bf16_f32 v72, v150, v151
    buffer_load_dwordx4 v4, s[4:7], s56 offen lds
    v_cvt_pk_bf16_f32 v73, v152, v153
    v_cvt_pk_bf16_f32 v74, v154, v155
    v_cvt_pk_bf16_f32 v75, v156, v157
    v_cvt_pk_bf16_f32 v76, v158, v159
    s_add_u32 m0, s54, 90112
    v_cvt_pk_bf16_f32 v77, v160, v161
    v_cvt_pk_bf16_f32 v44, v162, v163
    v_cvt_pk_bf16_f32 v45, v164, v165
    s_add_u32 s56, s56, s16
    s_nop 0
    v_cvt_pk_bf16_f32 v46, v166, v167
    v_cvt_pk_bf16_f32 v47, v168, v169
    buffer_load_dwordx4 v4, s[4:7], s56 offen lds
    v_cvt_pk_bf16_f32 v48, v170, v171
    v_cvt_pk_bf16_f32 v49, v172, v173
    s_add_u32 m0, s54, 94208
    v_cvt_pk_bf16_f32 v50, v174, v175
    v_cvt_pk_bf16_f32 v51, v176, v177
    v_cvt_pk_bf16_f32 v52, v178, v179
    s_add_u32 s56, s56, s16
    v_cvt_pk_bf16_f32 v53, v180, v181
    s_waitcnt lgkmcnt(0)
    buffer_load_dwordx4 v4, s[4:7], s56 offen lds
    v_pk_fma_f32 v[182:183], v[206:207], v[140:141], v[182:183] op_sel_hi:[1,0,1] neg_lo:[1,0,0] neg_hi:[1,0,0]
    v_pk_fma_f32 v[184:185], v[208:209], v[140:141], v[184:185] op_sel_hi:[1,0,1] neg_lo:[1,0,0] neg_hi:[1,0,0]
    s_add_u32 m0, s54, 98304
    v_pk_fma_f32 v[186:187], v[210:211], v[140:141], v[186:187] op_sel_hi:[1,0,1] neg_lo:[1,0,0] neg_hi:[1,0,0]
    v_pk_fma_f32 v[188:189], v[212:213], v[140:141], v[188:189] op_sel_hi:[1,0,1] neg_lo:[1,0,0] neg_hi:[1,0,0]
    v_pk_fma_f32 v[190:191], v[214:215], v[140:141], v[190:191] op_sel_hi:[1,0,1] neg_lo:[1,0,0] neg_hi:[1,0,0]
    s_add_u32 s56, s56, s17
    s_nop 0
    v_pk_fma_f32 v[192:193], v[216:217], v[140:141], v[192:193] op_sel_hi:[1,0,1] neg_lo:[1,0,0] neg_hi:[1,0,0]
    v_pk_fma_f32 v[194:195], v[218:219], v[140:141], v[194:195] op_sel_hi:[1,0,1] neg_lo:[1,0,0] neg_hi:[1,0,0]
    buffer_load_dwordx4 v4, s[4:7], s56 offen lds
    v_pk_fma_f32 v[196:197], v[220:221], v[140:141], v[196:197] op_sel_hi:[1,0,1] neg_lo:[1,0,0] neg_hi:[1,0,0]
    v_pk_fma_f32 v[198:199], v[222:223], v[140:141], v[198:199] op_sel_hi:[1,0,1] neg_lo:[1,0,0] neg_hi:[1,0,0]
    s_add_u32 m0, s54, 102400
    v_pk_fma_f32 v[200:201], v[224:225], v[140:141], v[200:201] op_sel_hi:[1,0,1] neg_lo:[1,0,0] neg_hi:[1,0,0]
    v_pk_mul_f32 v[182:183], v[182:183], v[226:227]
    v_pk_mul_f32 v[184:185], v[184:185], v[228:229]
    s_add_u32 s56, s56, s16
    s_nop 0
    v_pk_mul_f32 v[186:187], v[186:187], v[230:231]
    v_pk_mul_f32 v[188:189], v[188:189], v[232:233]
    buffer_load_dwordx4 v4, s[4:7], s56 offen lds
    v_pk_mul_f32 v[190:191], v[190:191], v[234:235]
    v_pk_mul_f32 v[192:193], v[192:193], v[236:237]
    s_add_u32 m0, s54, 106496
    v_pk_mul_f32 v[194:195], v[194:195], v[238:239]
    v_pk_mul_f32 v[196:197], v[196:197], v[240:241]
    v_pk_mul_f32 v[198:199], v[198:199], v[242:243]
    s_add_u32 s56, s56, s16
    s_nop 0
    v_pk_mul_f32 v[200:201], v[200:201], v[244:245]
    v_mfma_f32_16x16x16_bf16 v[146:149], v[44:45], v[70:71], v[112:115]
    buffer_load_dwordx4 v4, s[4:7], s56 offen lds
    s_add_u32 m0, s54, 110592
    v_cvt_pk_bf16_f32 v206, v198, v199
    v_cvt_pk_bf16_f32 v207, v200, v201
    v_mfma_f32_16x16x16_bf16 v[162:165], v[52:53], v[70:71], v[120:123]
    s_add_u32 s56, s56, s16
    s_nop 0
    v_cvt_pk_bf16_f32 v208, v182, v183
    buffer_load_dwordx4 v4, s[4:7], s56 offen lds
    v_mfma_f32_16x16x16_bf16 v[150:153], v[46:47], v[72:73], v[112:115]
    s_add_u32 m0, s54, 114688
    v_cvt_pk_bf16_f32 v209, v184, v185
    v_cvt_pk_bf16_f32 v210, v190, v191
    s_add_u32 s56, s56, s18
    s_nop 0
    v_mfma_f32_16x16x16_bf16 v[166:169], v[52:53], v[72:73], v[124:127]
    buffer_load_dwordx4 v4, s[4:7], s56 offen lds
    v_cvt_pk_bf16_f32 v211, v192, v193
    s_add_u32 m0, s54, 118784
    v_mfma_f32_16x16x16_bf16 v[154:157], v[48:49], v[74:75], v[112:115]
    s_add_u32 s56, s56, s16
    s_nop 0
    v_cvt_pk_bf16_f32 v212, v198, v199
    v_cvt_pk_bf16_f32 v213, v200, v201
    buffer_load_dwordx4 v4, s[4:7], s56 offen lds
    v_mfma_f32_16x16x16_bf16 v[170:173], v[44:45], v[74:75], v[116:119]
    s_add_u32 m0, s54, 122880
    v_cvt_pk_bf16_f32 v214, v186, v187
    v_mfma_f32_16x16x16_bf16 v[158:161], v[50:51], v[76:77], v[112:115]
    s_add_u32 s56, s56, s16
    s_nop 0
    buffer_load_dwordx4 v4, s[4:7], s56 offen lds
    v_cvt_pk_bf16_f32 v215, v188, v189
    v_cvt_pk_bf16_f32 v216, v194, v195
    v_mfma_f32_16x16x16_bf16 v[174:177], v[46:47], v[76:77], v[116:119]
    s_add_u32 m0, s54, 126976
    v_cvt_pk_bf16_f32 v217, v196, v197
    s_add_u32 s56, s56, s16
    v_max_f32 v146, v146, v162
    v_max_f32_e64 v147, v147, v163
    buffer_load_dwordx4 v4, s[4:7], s56 offen lds
    v_max_f32 v148, v148, v164
    v_max_f32 v149, v149, v165
    s_add_u32 m0, s54, 131072
    v_max_f32 v150, v150, v166
    v_max_f32 v151, v151, v167
    v_max_f32 v152, v152, v168
    s_add_u32 s56, s56, s17
    v_max_f32 v153, v153, v169
    v_max_f32 v154, v154, v170
    buffer_load_dwordx4 v4, s[4:7], s56 offen lds
    v_max_f32 v155, v155, v171
    v_max_f32 v156, v156, v172
    s_add_u32 m0, s54, 135168
    v_max_f32 v157, v157, v173
    v_max_f32 v158, v158, v174
    v_max_f32 v159, v159, v175
    s_add_u32 s56, s56, s16
    v_max_f32 v160, v160, v176
    v_max_f32 v161, v161, v177
    buffer_load_dwordx4 v4, s[4:7], s56 offen lds
    v_max3_f32 v164, v146, v147, v148
    v_max3_f32 v168, v150, v151, v152
    s_add_u32 m0, s54, 139264
    v_max3_f32 v172, v154, v155, v156
    v_max3_f32 v176, v158, v159, v160
    v_max_f32 v162, v164, v149
    s_add_u32 s56, s56, s16
    v_max_f32 v163, v164, v149
    v_max_f32 v166, v168, v153
    buffer_load_dwordx4 v4, s[4:7], s56 offen lds
    v_max_f32 v167, v168, v153
    v_max_f32 v170, v172, v157
    s_add_u32 m0, s54, 143360
    v_max_f32 v171, v172, v157
    v_max_f32 v174, v176, v161
    v_max_f32 v175, v176, v161
    s_add_u32 s56, s56, s16
    v_permlane16_swap_b32 v162, v163
    buffer_load_dwordx4 v4, s[4:7], s56 offen lds
    v_permlane16_swap_b32 v166, v167
    v_permlane16_swap_b32 v170, v171
    v_permlane16_swap_b32 v174, v175
    v_max_f32 v164, v162, v163
    v_max_f32 v165, v162, v163
    v_max_f32 v168, v166, v167
    v_max_f32 v169, v166, v167
    v_max_f32 v172, v170, v171
    v_max_f32 v173, v170, v171
    v_max_f32 v176, v174, v175
    v_max_f32 v177, v174, v175
    v_permlane32_swap_b32 v164, v165
    v_permlane32_swap_b32 v168, v169
    v_permlane32_swap_b32 v172, v173
    v_permlane32_swap_b32 v176, v177
    v_max_f32 v162, v164, v165
    v_max_f32 v166, v168, v169
    v_max_f32 v170, v172, v173
    v_max_f32 v174, v176, v177
    v_pk_add_f32 v[146:147], v[146:147], v[162:163] op_sel:[0,0] op_sel_hi:[1,0] neg_lo:[0,1] neg_hi:[0,1]
    v_pk_add_f32 v[148:149], v[148:149], v[162:163] op_sel:[0,0] op_sel_hi:[1,0] neg_lo:[0,1] neg_hi:[0,1]
    v_pk_add_f32 v[150:151], v[150:151], v[166:167] op_sel:[0,0] op_sel_hi:[1,0] neg_lo:[0,1] neg_hi:[0,1]
    v_pk_add_f32 v[152:153], v[152:153], v[166:167] op_sel:[0,0] op_sel_hi:[1,0] neg_lo:[0,1] neg_hi:[0,1]
    v_pk_add_f32 v[154:155], v[154:155], v[170:171] op_sel:[0,0] op_sel_hi:[1,0] neg_lo:[0,1] neg_hi:[0,1]
    v_pk_add_f32 v[156:157], v[156:157], v[170:171] op_sel:[0,0] op_sel_hi:[1,0] neg_lo:[0,1] neg_hi:[0,1]
    v_pk_add_f32 v[158:159], v[158:159], v[174:175] op_sel:[0,0] op_sel_hi:[1,0] neg_lo:[0,1] neg_hi:[0,1]
    v_pk_add_f32 v[160:161], v[160:161], v[174:175] op_sel:[0,0] op_sel_hi:[1,0] neg_lo:[0,1] neg_hi:[0,1]
    v_exp_f32 v146, v146
    v_exp_f32 v147, v147
    v_exp_f32 v148, v148
    v_exp_f32 v149, v149
    v_exp_f32 v150, v150
    v_exp_f32 v151, v151
    v_exp_f32 v152, v152
    v_exp_f32 v153, v153
    v_exp_f32 v154, v154
    v_exp_f32 v155, v155
    v_exp_f32 v156, v156
    v_exp_f32 v157, v157
    v_exp_f32 v158, v158
    v_exp_f32 v159, v159
    v_exp_f32 v160, v160
    v_exp_f32 v161, v161
    v_cvt_pk_bf16_f32 v228, v146, v147
    v_cvt_pk_bf16_f32 v229, v148, v149
    v_cvt_pk_bf16_f32 v232, v150, v151
    v_cvt_pk_bf16_f32 v233, v152, v153
    v_cvt_pk_bf16_f32 v236, v154, v155
    v_cvt_pk_bf16_f32 v237, v156, v157
    s_cmp_lg_u32 s48, 3
    s_cbranch_scc1 Lpi25
    s_load_dword s69, s[36:37], s68 offset:260 glc
Lpi25:
    v_cvt_pk_bf16_f32 v240, v158, v159
    v_cvt_pk_bf16_f32 v241, v160, v161
    v_and_b32 v226, v132, v228
    v_and_b32 v227, v133, v229
    v_and_b32 v228, v128, v228
    v_and_b32 v229, v129, v229
    v_and_b32 v230, v134, v232
    v_and_b32 v231, v135, v233
    v_and_b32 v232, v128, v232
    v_and_b32 v233, v129, v233
    v_and_b32 v234, v130, v236
    v_and_b32 v235, v131, v237
    v_and_b32 v236, v128, v236
    v_and_b32 v237, v129, v237
    v_and_b32 v238, v130, v240
    v_and_b32 v239, v131, v241
    v_and_b32 v240, v128, v240
    v_and_b32 v241, v129, v241
    v_mfma_f32_16x16x32_bf16 v[146:149], v[32:35], v[226:229], 0
    v_mfma_f32_16x16x32_bf16 v[150:153], v[32:35], v[230:233], 0
    v_mfma_f32_16x16x32_bf16 v[154:157], v[32:35], v[234:237], 0
    v_mfma_f32_16x16x32_bf16 v[158:161], v[32:35], v[238:241], 0
    v_mfma_f32_16x16x32_bf16 v[182:185], v[206:209], v[226:229], 0
    v_mfma_f32_16x16x32_bf16 v[186:189], v[212:215], v[230:233], 0
    v_mfma_f32_16x16x32_bf16 v[190:193], v[208:211], v[234:237], 0
    v_mfma_f32_16x16x32_bf16 v[194:197], v[214:217], v[238:241], 0
    s_nop 0
    v_rcp_f32 v146, v146
    v_rcp_f32 v150, v150
    v_rcp_f32 v154, v154
    v_rcp_f32_e64 v158, v158
    v_pk_mul_f32 v[182:183], v[182:183], v[146:147] op_sel:[0,0] op_sel_hi:[1,0]
    v_pk_mul_f32 v[184:185], v[184:185], v[146:147] op_sel:[0,0] op_sel_hi:[1,0]
    v_pk_mul_f32 v[186:187], v[186:187], v[150:151] op_sel:[0,0] op_sel_hi:[1,0]
    v_pk_mul_f32 v[188:189], v[188:189], v[150:151] op_sel:[0,0] op_sel_hi:[1,0]
    s_cmp_lg_u32 s48, 3
    s_cbranch_scc1 Lpolld27
    s_waitcnt lgkmcnt(0)
    s_cmp_lt_u32 s69, 16
    s_cbranch_scc1 Lpoll26
Lpolld27:
    s_barrier
    s_mov_b32 s98, 0
    s_nop 0
    buffer_load_dwordx4 a[64:67], v18, s[36:39], s98 offen offset:0 sc1
    buffer_load_dwordx4 a[68:71], v18, s[36:39], s98 offen offset:1024 sc1
    v_pk_mul_f32 v[190:191], v[190:191], v[154:155] op_sel:[0,0] op_sel_hi:[1,0]
    v_pk_mul_f32 v[192:193], v[192:193], v[154:155] op_sel:[0,0] op_sel_hi:[1,0]
    s_waitcnt vmcnt(2)
    s_barrier
    v_pk_mul_f32 v[194:195], v[194:195], v[158:159] op_sel:[0,0] op_sel_hi:[1,0]
    s_add_u32 s81, s92, 0
    v_add_u32 v98, s81, v96
    v_add_u32_e64 v99, s81, v97
    ds_read_b64_tr_b16 a[192:193], v98 offset:0
    v_pk_mul_f32 v[196:197], v[196:197], v[158:159] op_sel:[0,0] op_sel_hi:[1,0]
    ds_read_b64_tr_b16 a[194:195], v98 offset:512
    v_cvt_pk_bf16_f32 v78, v182, v183
    ds_read_b64_tr_b16 a[196:197], v99 offset:0
    v_cvt_pk_bf16_f32 v79, v184, v185
    ds_read_b64_tr_b16 a[198:199], v99 offset:512
    v_cvt_pk_bf16_f32 v80, v186, v187
    ds_read_b64_tr_b16 a[200:201], v98 offset:2048
    v_cvt_pk_bf16_f32 v81, v188, v189
    ds_read_b64_tr_b16 a[202:203], v98 offset:2560
    v_cvt_pk_bf16_f32 v82, v190, v191
    ds_read_b64_tr_b16 a[204:205], v99 offset:2048
    v_cvt_pk_bf16_f32 v83, v192, v193
    ds_read_b64_tr_b16 a[206:207], v99 offset:2560
    v_cvt_pk_bf16_f32 v84, v194, v195
    ds_read_b64_tr_b16 a[208:209], v98 offset:4096
    v_cvt_pk_bf16_f32 v85, v196, v197
    ds_read_b64_tr_b16 a[210:211], v98 offset:4608
    v_permlane16_swap_b32 v78, v80
    ds_read_b64_tr_b16 a[212:213], v99 offset:4096
    v_permlane16_swap_b32 v79, v81
    ds_read_b64_tr_b16 a[214:215], v99 offset:4608
    v_permlane16_swap_b32 v82, v84
    v_permlane16_swap_b32 v83, v85
    buffer_store_dwordx4 v[78:81], v86, s[36:39], 0 offen sc1
    buffer_store_dwordx4 v[82:85], v87, s[36:39], 0 offen sc1
    s_waitcnt lgkmcnt(8)
    s_nop 0
    v_mfma_f32_16x16x32_bf16 v[146:149], a[192:195], v[36:39], 0
    ds_read_b64_tr_b16 a[216:217], v98 offset:6144
    ds_read_b64_tr_b16 a[218:219], v98 offset:6656
    buffer_load_dwordx4 a[72:75], v18, s[36:39], s98 offen offset:2048 sc1
    v_mfma_f32_16x16x32_bf16 v[150:153], a[196:199], v[36:39], 0
    ds_read_b64_tr_b16 a[220:221], v99 offset:6144
    ds_read_b64_tr_b16 a[222:223], v99 offset:6656
    s_waitcnt lgkmcnt(8)
    s_nop 0
    v_mfma_f32_16x16x32_bf16 v[146:149], a[200:203], v[36:39], v[146:149]
    ds_read_b64_tr_b16 a[192:193], v98 offset:8192
    ds_read_b64_tr_b16 a[194:195], v98 offset:8704
    v_mfma_f32_16x16x32_bf16 v[150:153], a[204:207], v[36:39], v[150:153]
    ds_read_b64_tr_b16 a[196:197], v99 offset:8192
    ds_read_b64_tr_b16 a[198:199], v99 offset:8704
    buffer_load_dwordx4 a[76:79], v18, s[36:39], s98 offen offset:3072 sc1
    s_waitcnt lgkmcnt(8)
    s_nop 0
    v_mfma_f32_16x16x32_bf16 v[146:149], a[208:211], v[36:39], v[146:149]
    ds_read_b64_tr_b16 a[200:201], v98 offset:10240
    ds_read_b64_tr_b16 a[202:203], v98 offset:10752
    s_mov_b32 s98, 4096
    v_mfma_f32_16x16x32_bf16 v[150:153], a[212:215], v[36:39], v[150:153]
    ds_read_b64_tr_b16 a[204:205], v99 offset:10240
    ds_read_b64_tr_b16 a[206:207], v99 offset:10752
    buffer_load_dwordx4 a[80:83], v18, s[36:39], s98 offen offset:0 sc1
    s_waitcnt lgkmcnt(8)
    s_nop 0
    v_mfma_f32_16x16x32_bf16 v[146:149], a[216:219], v[36:39], v[146:149]
    ds_read_b64_tr_b16 a[208:209], v98 offset:12288
    ds_read_b64_tr_b16 a[210:211], v98 offset:12800
    v_mfma_f32_16x16x32_bf16 v[150:153], a[220:223], v[36:39], v[150:153]
    ds_read_b64_tr_b16 a[212:213], v99 offset:12288
    ds_read_b64_tr_b16 a[214:215], v99 offset:12800
    buffer_load_dwordx4 a[84:87], v18, s[36:39], s98 offen offset:1024 sc1
    s_waitcnt lgkmcnt(8)
    s_nop 0
    v_mfma_f32_16x16x32_bf16 v[146:149], a[192:195], v[36:39], v[146:149]
    ds_read_b64_tr_b16 a[216:217], v98 offset:14336
    ds_read_b64_tr_b16 a[218:219], v98 offset:14848
    v_mfma_f32_16x16x32_bf16 v[150:153], a[196:199], v[36:39], v[150:153]
    ds_read_b64_tr_b16 a[220:221], v99 offset:14336
    ds_read_b64_tr_b16 a[222:223], v99 offset:14848
    s_add_u32 s81, s92, 81920
    v_add_u32 v98, s81, v96
    v_add_u32 v99, s81, v97
    buffer_load_dwordx4 a[88:91], v18, s[36:39], s98 offen offset:2048 sc1
    s_waitcnt lgkmcnt(8)
    s_nop 0
    v_mfma_f32_16x16x32_bf16 v[146:149], a[200:203], v[36:39], v[146:149]
    ds_read_b64_tr_b16 a[192:193], v98 offset:0
    ds_read_b64_tr_b16 a[194:195], v98 offset:512
    v_mfma_f32_16x16x32_bf16 v[150:153], a[204:207], v[36:39], v[150:153]
    ds_read_b64_tr_b16 a[196:197], v99 offset:0
    ds_read_b64_tr_b16 a[198:199], v99 offset:512
    s_waitcnt lgkmcnt(8)
    s_nop 0
    v_mfma_f32_16x16x32_bf16 v[146:149], a[208:211], v[36:39], v[146:149]
    ds_read_b64_tr_b16 a[200:201], v98 offset:2048
    ds_read_b64_tr_b16 a[202:203], v98 offset:2560
    buffer_load_dwordx4 a[92:95], v18, s[36:39], s98 offen offset:3072 sc1
    v_mfma_f32_16x16x32_bf16 v[150:153], a[212:215], v[36:39], v[150:153]
    ds_read_b64_tr_b16 a[204:205], v99 offset:2048
    ds_read_b64_tr_b16 a[206:207], v99 offset:2560
    s_mov_b32 s98, 8192
    s_waitcnt lgkmcnt(8)
    s_nop 0
    v_mfma_f32_16x16x32_bf16 v[146:149], a[216:219], v[36:39], v[146:149]
    ds_read_b64_tr_b16 a[208:209], v98 offset:4096
    ds_read_b64_tr_b16 a[210:211], v98 offset:4608
    buffer_load_dwordx4 a[96:99], v18, s[36:39], s98 offen offset:0 sc1
    v_mfma_f32_16x16x32_bf16 v[150:153], a[220:223], v[36:39], v[150:153]
    ds_read_b64_tr_b16 a[212:213], v99 offset:4096
    ds_read_b64_tr_b16 a[214:215], v99 offset:4608
    s_waitcnt lgkmcnt(8)
    s_nop 0
    v_mfma_f32_16x16x32_bf16 v[154:157], a[192:195], v[36:39], 0
    ds_read_b64_tr_b16 a[216:217], v98 offset:6144
    ds_read_b64_tr_b16 a[218:219], v98 offset:6656
    buffer_load_dwordx4 a[100:103], v18, s[36:39], s98 offen offset:1024 sc1
    v_mfma_f32_16x16x32_bf16 v[158:161], a[196:199], v[36:39], 0
    ds_read_b64_tr_b16 a[220:221], v99 offset:6144
    ds_read_b64_tr_b16 a[222:223], v99 offset:6656
    s_waitcnt lgkmcnt(8)
    s_nop 0
    v_mfma_f32_16x16x32_bf16 v[154:157], a[200:203], v[36:39], v[154:157]
    ds_read_b64_tr_b16 a[192:193], v98 offset:8192
    ds_read_b64_tr_b16 a[194:195], v98 offset:8704
    buffer_load_dwordx4 a[104:107], v18, s[36:39], s98 offen offset:2048 sc1
    v_mfma_f32_16x16x32_bf16 v[158:161], a[204:207], v[36:39], v[158:161]
    ds_read_b64_tr_b16 a[196:197], v99 offset:8192
    ds_read_b64_tr_b16 a[198:199], v99 offset:8704
    s_waitcnt lgkmcnt(8)
    s_nop 0
    v_mfma_f32_16x16x32_bf16 v[154:157], a[208:211], v[36:39], v[154:157]
    ds_read_b64_tr_b16 a[200:201], v98 offset:10240
    ds_read_b64_tr_b16 a[202:203], v98 offset:10752
    buffer_load_dwordx4 a[108:111], v18, s[36:39], s98 offen offset:3072 sc1
    v_mfma_f32_16x16x32_bf16 v[158:161], a[212:215], v[36:39], v[158:161]
    s_mov_b32 exec_lo, 0x00030003
    s_mov_b32 exec_hi, 0x00030003
    ds_write2_b32 v106, v146, v147 offset0:0 offset1:4
    ds_write2_b32 v106, v148, v149 offset0:8 offset1:12
    ds_write2_b32 v106, v150, v151 offset0:128 offset1:132
    ds_write2_b32 v106, v152, v153 offset0:136 offset1:140
    s_mov_b64 exec, -1
    s_nop 0
    v_add_u32 v106, 1024, v106
    ds_read_b64_tr_b16 a[204:205], v99 offset:10240
    ds_read_b64_tr_b16 a[206:207], v99 offset:10752
    s_mov_b32 s98, 12288
    buffer_load_dwordx4 a[112:115], v18, s[36:39], s98 offen offset:0 sc1
    s_waitcnt lgkmcnt(12)
    s_nop 0
    v_mfma_f32_16x16x32_bf16 v[154:157], a[216:219], v[36:39], v[154:157]
    ds_read_b64_tr_b16 a[208:209], v98 offset:12288
    ds_read_b64_tr_b16 a[210:211], v98 offset:12800
    v_mfma_f32_16x16x32_bf16 v[158:161], a[220:223], v[36:39], v[158:161]
    ds_read_b64_tr_b16 a[212:213], v99 offset:12288
    ds_read_b64_tr_b16 a[214:215], v99 offset:12800
    s_waitcnt lgkmcnt(12)
    s_nop 0
    v_mfma_f32_16x16x32_bf16 v[154:157], a[192:195], v[36:39], v[154:157]
    ds_read_b64_tr_b16 a[216:217], v98 offset:14336
    ds_read_b64_tr_b16 a[218:219], v98 offset:14848
    buffer_load_dwordx4 a[116:119], v18, s[36:39], s98 offen offset:1024 sc1
    v_mfma_f32_16x16x32_bf16 v[158:161], a[196:199], v[36:39], v[158:161]
    ds_read_b64_tr_b16 a[220:221], v99 offset:14336
    ds_read_b64_tr_b16 a[222:223], v99 offset:14848
    s_waitcnt lgkmcnt(8)
    s_nop 0
    v_mfma_f32_16x16x32_bf16 v[154:157], a[200:203], v[36:39], v[154:157]
    buffer_load_dwordx4 a[120:123], v18, s[36:39], s98 offen offset:2048 sc1
    v_mfma_f32_16x16x32_bf16 v[158:161], a[204:207], v[36:39], v[158:161]
    s_waitcnt lgkmcnt(4)
    s_nop 0
    v_mfma_f32_16x16x32_bf16 v[154:157], a[208:211], v[36:39], v[154:157]
    buffer_load_dwordx4 a[124:127], v18, s[36:39], s98 offen offset:3072 sc1
    v_mfma_f32_16x16x32_bf16 v[158:161], a[212:215], v[36:39], v[158:161]
    s_mov_b32 s98, 16384
    s_waitcnt lgkmcnt(0)
    s_nop 0
    v_mfma_f32_16x16x32_bf16 v[154:157], a[216:219], v[36:39], v[154:157]
    buffer_load_dwordx4 a[128:131], v18, s[36:39], s98 offen offset:0 sc1
    v_mfma_f32_16x16x32_bf16 v[158:161], a[220:223], v[36:39], v[158:161]
    s_waitcnt vmcnt(15)
    s_barrier
    s_cmp_lg_u32 s48, 0
    s_cbranch_scc1 Lsg28
    s_atomic_add s1, s[36:37], s67 offset:0
Lsg28:
    buffer_load_dwordx4 a[132:135], v18, s[36:39], s98 offen offset:1024 sc1
    s_cmp_eq_u32 s49, 7
    s_cbranch_scc1 Lidle1
    ds_read_b64_tr_b16 a[192:193], v96 offset:0
    ds_read_b64_tr_b16 a[194:195], v96 offset:512
    ds_read_b64_tr_b16 a[196:197], v97 offset:0
    ds_read_b64_tr_b16 a[198:199], v97 offset:512
    ds_read_b64_tr_b16 a[200:201], v96 offset:2048
    ds_read_b64_tr_b16 a[202:203], v96 offset:2560
    ds_read_b64_tr_b16 a[204:205], v97 offset:2048
    ds_read_b64_tr_b16 a[206:207], v97 offset:2560
    ds_read_b64_tr_b16 a[208:209], v96 offset:4096
    ds_read_b64_tr_b16 a[210:211], v96 offset:4608
    ds_read_b64_tr_b16 a[212:213], v97 offset:4096
    ds_read_b64_tr_b16 a[214:215], v97 offset:4608
    s_waitcnt lgkmcnt(8)
    s_nop 0
    v_mfma_f32_32x32x16_bf16 v[112:127], a[192:195], a[64:67], 0
    ds_read_b64_tr_b16 a[216:217], v96 offset:6144
    ds_read_b64_tr_b16 a[218:219], v96 offset:6656
    buffer_load_dwordx4 a[136:139], v18, s[36:39], s98 offen offset:2048 sc1
    v_mfma_f32_32x32x16_bf16 v[128:143], a[196:199], a[64:67], 0
    s_mov_b32 exec_lo, 0x00030003
    s_mov_b32 exec_hi, 0x00030003
    ds_write2_b32 v106, v154, v155 offset0:0 offset1:4
    ds_write2_b32 v106, v156, v157 offset0:8 offset1:12
    ds_write2_b32 v106, v158, v159 offset0:128 offset1:132
    ds_write2_b32 v106, v160, v161 offset0:136 offset1:140
    s_mov_b64 exec, -1
    ds_read_b64_tr_b16 a[220:221], v97 offset:6144
    ds_read_b64_tr_b16 a[222:223], v97 offset:6656
    s_waitcnt lgkmcnt(12)
    v_mfma_f32_32x32x16_bf16 v[112:127], a[200:203], a[68:71], v[112:127]
    ds_read_b64_tr_b16 a[192:193], v96 offset:8192
    ds_read_b64_tr_b16 a[194:195], v96 offset:8704
    buffer_load_dwordx4 a[140:143], v18, s[36:39], s98 offen offset:3072 sc1
    v_mfma_f32_32x32x16_bf16 v[128:143], a[204:207], a[68:71], v[128:143]
    ds_read_b64_tr_b16 a[196:197], v97 offset:8192
    ds_read_b64_tr_b16 a[198:199], v97 offset:8704
    s_mov_b32 s98, 20480
    s_waitcnt vmcnt(17) lgkmcnt(12)
    s_nop 0
    v_mfma_f32_32x32x16_bf16 v[112:127], a[208:211], a[72:75], v[112:127]
    ds_read_b64_tr_b16 a[200:201], v96 offset:10240
    ds_read_b64_tr_b16 a[202:203], v96 offset:10752
    buffer_load_dwordx4 a[144:147], v18, s[36:39], s98 offen offset:0 sc1
    v_mfma_f32_32x32x16_bf16 v[128:143], a[212:215], a[72:75], v[128:143]
    ds_read_b64_tr_b16 a[204:205], v97 offset:10240
    ds_read_b64_tr_b16 a[206:207], v97 offset:10752
    s_waitcnt vmcnt(17) lgkmcnt(8)
    s_nop 0
    v_mfma_f32_32x32x16_bf16 v[112:127], a[216:219], a[76:79], v[112:127]
    ds_read_b64_tr_b16 a[208:209], v96 offset:12288
    ds_read_b64_tr_b16 a[210:211], v96 offset:12800
    buffer_load_dwordx4 a[148:151], v18, s[36:39], s98 offen offset:1024 sc1
    v_mfma_f32_32x32x16_bf16 v[128:143], a[220:223], a[76:79], v[128:143]
    ds_read_b64_tr_b16 a[212:213], v97 offset:12288
    ds_read_b64_tr_b16 a[214:215], v97 offset:12800
    s_barrier
    s_waitcnt vmcnt(17) lgkmcnt(8)
    v_mfma_f32_32x32x16_bf16 v[112:127], a[192:195], a[80:83], v[112:127]
    ds_read_b64_tr_b16 a[216:217], v96 offset:14336
    ds_read_b64_tr_b16 a[218:219], v96 offset:14848
    buffer_load_dwordx4 a[152:155], v18, s[36:39], s98 offen offset:2048 sc1
    v_mfma_f32_32x32x16_bf16 v[128:143], a[196:199], a[80:83], v[128:143]
    ds_read_b64_tr_b16 a[220:221], v97 offset:14336
    ds_read_b64_tr_b16 a[222:223], v97 offset:14848
    ds_read_b128 v[208:211], v108 offset:0
    s_waitcnt vmcnt(17) lgkmcnt(9)
    s_nop 0
    v_mfma_f32_32x32x16_bf16 v[112:127], a[200:203], a[84:87], v[112:127]
    ds_read_b64_tr_b16 a[192:193], v96 offset:16384
    ds_read_b64_tr_b16 a[194:195], v96 offset:16896
    ds_read_b128 v[212:215], v108 offset:1024
    buffer_load_dwordx4 a[156:159], v18, s[36:39], s98 offen offset:3072 sc1
    v_mfma_f32_32x32x16_bf16 v[128:143], a[204:207], a[84:87], v[128:143]
    ds_read_b64_tr_b16 a[196:197], v97 offset:16384
    ds_read_b64_tr_b16 a[198:199], v97 offset:16896
    buffer_load_dwordx4 v[176:179], v24, s[36:39], 0 offen offset:0 sc1
    s_waitcnt vmcnt(18) lgkmcnt(10)
    s_nop 0
    v_mfma_f32_32x32x16_bf16 v[112:127], a[208:211], a[88:91], v[112:127]
    ds_read_b64_tr_b16 a[200:201], v96 offset:18432
    ds_read_b64_tr_b16 a[202:203], v96 offset:18944
    v_mfma_f32_32x32x16_bf16 v[128:143], a[212:215], a[88:91], v[128:143]
    ds_read_b64_tr_b16 a[204:205], v97 offset:18432
    ds_read_b64_tr_b16 a[206:207], v97 offset:18944
    buffer_load_dwordx4 v[180:183], v24, s[36:39], 0 offen offset:1024 sc1
    s_waitcnt vmcnt(18) lgkmcnt(10)
    s_nop 0
    v_mfma_f32_32x32x16_bf16 v[112:127], a[216:219], a[92:95], v[112:127]
    ds_read_b64_tr_b16 a[208:209], v96 offset:20480
    ds_read_b64_tr_b16 a[210:211], v96 offset:20992
    v_mfma_f32_32x32x16_bf16 v[128:143], a[220:223], a[92:95], v[128:143]
    ds_read_b64_tr_b16 a[212:213], v97 offset:20480
    ds_read_b64_tr_b16 a[214:215], v97 offset:20992
    buffer_load_dwordx4 v[184:187], v24, s[36:39], 0 offen offset:2048 sc1
    s_waitcnt vmcnt(18) lgkmcnt(8)
    s_nop 0
    v_mfma_f32_32x32x16_bf16 v[112:127], a[192:195], a[96:99], v[112:127]
    ds_read_b64_tr_b16 a[216:217], v96 offset:22528
    ds_read_b64_tr_b16 a[218:219], v96 offset:23040
    v_mfma_f32_32x32x16_bf16 v[128:143], a[196:199], a[96:99], v[128:143]
    ds_read_b64_tr_b16 a[220:221], v97 offset:22528
    ds_read_b64_tr_b16 a[222:223], v97 offset:23040
    v_add_f32_e64 v208, v208, v209
    buffer_load_dwordx4 v[188:191], v24, s[36:39], 0 offen offset:3072 sc1
    s_waitcnt vmcnt(18) lgkmcnt(8)
    s_nop 0
    v_mfma_f32_32x32x16_bf16 v[112:127], a[200:203], a[100:103], v[112:127]
    ds_read_b64_tr_b16 a[192:193], v96 offset:24576
    ds_read_b64_tr_b16 a[194:195], v96 offset:25088
    v_mfma_f32_32x32x16_bf16 v[128:143], a[204:207], a[100:103], v[128:143]
    ds_read_b64_tr_b16 a[196:197], v97 offset:24576
    ds_read_b64_tr_b16 a[198:199], v97 offset:25088
    v_add_f32_e64 v210, v210, v211
    s_mov_b32 s98, 24576
    s_waitcnt vmcnt(17) lgkmcnt(8)
    s_nop 0
    v_mfma_f32_32x32x16_bf16 v[112:127], a[208:211], a[104:107], v[112:127]
    ds_read_b64_tr_b16 a[200:201], v96 offset:26624
    ds_read_b64_tr_b16 a[202:203], v96 offset:27136
    v_add_f32_e64 v208, v208, v210
    buffer_load_dwordx4 a[160:163], v18, s[36:39], s98 offen offset:0 sc1
    v_mfma_f32_32x32x16_bf16 v[128:143], a[212:215], a[104:107], v[128:143]
    ds_read_b64_tr_b16 a[204:205], v97 offset:26624
    ds_read_b64_tr_b16 a[206:207], v97 offset:27136
    s_waitcnt vmcnt(17) lgkmcnt(8)
    s_nop 0
    v_mfma_f32_32x32x16_bf16 v[112:127], a[216:219], a[108:111], v[112:127]
    ds_read_b64_tr_b16 a[208:209], v96 offset:28672
    ds_read_b64_tr_b16 a[210:211], v96 offset:29184
    ds_write_b32 v109, v208 offset:0
    buffer_load_dwordx4 a[164:167], v18, s[36:39], s98 offen offset:1024 sc1
    v_mfma_f32_32x32x16_bf16 v[128:143], a[220:223], a[108:111], v[128:143]
    ds_read_b64_tr_b16 a[212:213], v97 offset:28672
    ds_read_b64_tr_b16 a[214:215], v97 offset:29184
    v_add_f32 v212, v212, v213
    s_waitcnt vmcnt(17) lgkmcnt(9)
    v_mfma_f32_32x32x16_bf16 v[112:127], a[192:195], a[112:115], v[112:127]
    ds_read_b64_tr_b16 a[216:217], v96 offset:30720
    ds_read_b64_tr_b16 a[218:219], v96 offset:31232
    buffer_load_dwordx4 a[168:171], v18, s[36:39], s98 offen offset:2048 sc1
    v_mfma_f32_32x32x16_bf16 v[128:143], a[196:199], a[112:115], v[128:143]
    ds_read_b64_tr_b16 a[220:221], v97 offset:30720
    ds_read_b64_tr_b16 a[222:223], v97 offset:31232
    v_add_f32 v214, v214, v215
    s_waitcnt vmcnt(17) lgkmcnt(9)
    v_mfma_f32_32x32x16_bf16 v[112:127], a[200:203], a[116:119], v[112:127]
    ds_read_b64_tr_b16 a[192:193], v96 offset:32768
    ds_read_b64_tr_b16 a[194:195], v96 offset:33280
    v_add_f32_e64 v212, v212, v214
    buffer_load_dwordx4 a[172:175], v18, s[36:39], s98 offen offset:3072 sc1
    v_mfma_f32_32x32x16_bf16 v[128:143], a[204:207], a[116:119], v[128:143]
    ds_read_b64_tr_b16 a[196:197], v97 offset:32768
    ds_read_b64_tr_b16 a[198:199], v97 offset:33280
    ds_write_b32 v109, v212 offset:256
    s_mov_b32 s98, 28672
    s_waitcnt vmcnt(17) lgkmcnt(9)
    s_nop 0
    v_mfma_f32_32x32x16_bf16 v[112:127], a[208:211], a[120:123], v[112:127]
    ds_read_b64_tr_b16 a[200:201], v96 offset:34816
    ds_read_b64_tr_b16 a[202:203], v96 offset:35328
    buffer_load_dwordx4 a[176:179], v18, s[36:39], s98 offen offset:0 sc1
    v_mfma_f32_32x32x16_bf16 v[128:143], a[212:215], a[120:123], v[128:143]
    ds_read_b64_tr_b16 a[204:205], v97 offset:34816
    ds_read_b64_tr_b16 a[206:207], v97 offset:35328
    ds_read_b128 v[192:195], v107 offset:0
    s_waitcnt vmcnt(17) lgkmcnt(10)
    s_nop 0
    v_mfma_f32_32x32x16_bf16 v[112:127], a[216:219], a[124:127], v[112:127]
    ds_read_b64_tr_b16 a[208:209], v96 offset:36864
    ds_read_b64_tr_b16 a[210:211], v96 offset:37376
    ds_read_b128 v[196:199], v107 offset:16
    buffer_load_dwordx4 a[180:183], v18, s[36:39], s98 offen offset:1024 sc1
    v_mfma_f32_32x32x16_bf16 v[128:143], a[220:223], a[124:127], v[128:143]
    ds_read_b64_tr_b16 a[212:213], v97 offset:36864
    ds_read_b64_tr_b16 a[214:215], v97 offset:37376
    s_waitcnt vmcnt(17) lgkmcnt(11)
    s_nop 0
    v_mfma_f32_32x32x16_bf16 v[112:127], a[192:195], a[128:131], v[112:127]
    ds_read_b64_tr_b16 a[216:217], v96 offset:38912
    ds_read_b64_tr_b16 a[218:219], v96 offset:39424
    ds_read_b128 v[200:203], v107 offset:32
    buffer_load_dwordx4 a[184:187], v18, s[36:39], s98 offen offset:2048 sc1
    v_mfma_f32_32x32x16_bf16 v[128:143], a[196:199], a[128:131], v[128:143]
    ds_read_b64_tr_b16 a[220:221], v97 offset:38912
    ds_read_b64_tr_b16 a[222:223], v97 offset:39424
    ds_read_b128 v[204:207], v107 offset:48
    s_waitcnt vmcnt(17) lgkmcnt(12)
    s_nop 0
    v_mfma_f32_32x32x16_bf16 v[112:127], a[200:203], a[132:135], v[112:127]
    ds_read_b64_tr_b16 a[192:193], v96 offset:40960
    ds_read_b64_tr_b16 a[194:195], v96 offset:41472
    buffer_load_dwordx4 a[188:191], v18, s[36:39], s98 offen offset:3072 sc1
    v_mfma_f32_32x32x16_bf16 v[128:143], a[204:207], a[132:135], v[128:143]
    ds_read_b64_tr_b16 a[196:197], v97 offset:40960
    ds_read_b64_tr_b16 a[198:199], v97 offset:41472
    s_waitcnt vmcnt(17) lgkmcnt(10)
    s_nop 0
    v_mfma_f32_32x32x16_bf16 v[112:127], a[208:211], a[136:139], v[112:127]
    ds_read_b64_tr_b16 a[200:201], v96 offset:43008
    ds_read_b64_tr_b16 a[202:203], v96 offset:43520
    v_mfma_f32_32x32x16_bf16 v[128:143], a[212:215], a[136:139], v[128:143]
    ds_read_b64_tr_b16 a[204:205], v97 offset:43008
    ds_read_b64_tr_b16 a[206:207], v97 offset:43520
    s_waitcnt vmcnt(16) lgkmcnt(9)
    s_nop 0
    v_mfma_f32_32x32x16_bf16 v[112:127], a[216:219], a[140:143], v[112:127]
    ds_read_b64_tr_b16 a[208:209], v96 offset:45056
    ds_read_b64_tr_b16 a[210:211], v96 offset:45568
    v_mfma_f32_32x32x16_bf16 v[128:143], a[220:223], a[140:143], v[128:143]
    ds_read_b64_tr_b16 a[212:213], v97 offset:45056
    ds_read_b64_tr_b16 a[214:215], v97 offset:45568
    s_barrier
    s_waitcnt vmcnt(15) lgkmcnt(8)
    v_mfma_f32_32x32x16_bf16 v[112:127], a[192:195], a[144:147], v[112:127]
    ds_read_b64_tr_b16 a[216:217], v96 offset:47104
    ds_read_b64_tr_b16 a[218:219], v96 offset:47616
    s_waitcnt vmcnt(8)
    s_nop 0
    s_add_u32 m0, s54, 65536
    v_mfma_f32_32x32x16_bf16 v[128:143], a[196:199], a[144:147], v[128:143]
    ds_read_b64_tr_b16 a[220:221], v97 offset:47104
    ds_read_b64_tr_b16 a[222:223], v97 offset:47616
    v_add_f32 v176, v176, v184
    v_add_f32 v177, v177, v185
    buffer_load_dwordx4 v2, s[12:15], s53 offen lds
    s_waitcnt lgkmcnt(8)
    s_nop 0
    v_mfma_f32_32x32x16_bf16 v[112:127], a[200:203], a[148:151], v[112:127]
    ds_read_b64_tr_b16 a[192:193], v96 offset:49152
    ds_read_b64_tr_b16 a[194:195], v96 offset:49664
    v_add_f32 v178, v178, v186
    v_add_f32 v179, v179, v187
    s_add_u32 m0, s54, 69632
    v_mfma_f32_32x32x16_bf16 v[128:143], a[204:207], a[148:151], v[128:143]
    ds_read_b64_tr_b16 a[196:197], v97 offset:49152
    ds_read_b64_tr_b16 a[198:199], v97 offset:49664
    v_add_f32_e64 v180, v180, v188
    s_add_u32 s80, s53, 32768
    s_waitcnt lgkmcnt(8)
    s_nop 0
    v_mfma_f32_32x32x16_bf16 v[112:127], a[208:211], a[152:155], v[112:127]
    ds_read_b64_tr_b16 a[200:201], v96 offset:51200
    ds_read_b64_tr_b16 a[202:203], v96 offset:51712
    v_add_f32 v181, v181, v189
    v_add_f32 v182, v182, v190
    buffer_load_dwordx4 v2, s[12:15], s80 offen lds
    s_add_u32 m0, s54, 73728
    v_mfma_f32_32x32x16_bf16 v[128:143], a[212:215], a[152:155], v[128:143]
    ds_read_b64_tr_b16 a[204:205], v97 offset:51200
    ds_read_b64_tr_b16 a[206:207], v97 offset:51712
    v_add_f32 v183, v183, v191
    v_add_f32 v176, v176, v180
    s_add_u32 s80, s53, 65536
    s_waitcnt lgkmcnt(8)
    s_nop 0
    v_mfma_f32_32x32x16_bf16 v[112:127], a[216:219], a[156:159], v[112:127]
    ds_read_b64_tr_b16 a[208:209], v96 offset:53248
    ds_read_b64_tr_b16 a[210:211], v96 offset:53760
    v_add_f32_e64 v177, v177, v181
    buffer_load_dwordx4 v2, s[12:15], s80 offen lds
    v_mfma_f32_32x32x16_bf16 v[128:143], a[220:223], a[156:159], v[128:143]
    ds_read_b64_tr_b16 a[212:213], v97 offset:53248
    ds_read_b64_tr_b16 a[214:215], v97 offset:53760
    v_add_f32 v178, v178, v182
    v_add_f32 v179, v179, v183
    s_add_u32 m0, s54, 77824
    s_waitcnt vmcnt(10) lgkmcnt(8)
    s_nop 0
    v_mfma_f32_32x32x16_bf16 v[112:127], a[192:195], a[160:163], v[112:127]
    ds_read_b64_tr_b16 a[216:217], v96 offset:55296
    ds_read_b64_tr_b16 a[218:219], v96 offset:55808
    s_lshl_b32 s81, s48, 10
    s_nop 0
    s_add_u32 s81, s81, 147456
    s_add_u32 s80, s53, 98304
    v_mfma_f32_32x32x16_bf16 v[128:143], a[196:199], a[160:163], v[128:143]
    ds_read_b64_tr_b16 a[220:221], v97 offset:55296
    ds_read_b64_tr_b16 a[222:223], v97 offset:55808
    v_lshl_add_u32 v180, v1, 4, s81
    buffer_load_dwordx4 v2, s[12:15], s80 offen lds
    s_add_u32 m0, s54, 151552
    s_waitcnt vmcnt(10) lgkmcnt(8)
    s_nop 0
    v_mfma_f32_32x32x16_bf16 v[112:127], a[200:203], a[164:167], v[112:127]
    ds_read_b64_tr_b16 a[192:193], v96 offset:57344
    ds_read_b64_tr_b16 a[194:195], v96 offset:57856
    v_lshl_add_u32 v181, v1, 2, s81
    ds_write_b128 v180, v[176:179]
    v_mfma_f32_32x32x16_bf16 v[128:143], a[204:207], a[164:167], v[128:143]
    ds_read_b64_tr_b16 a[196:197], v97 offset:57344
    ds_read_b64_tr_b16 a[198:199], v97 offset:57856
    ds_read2st64_b32 v[184:185], v181 offset0:0 offset1:1
    ds_read2st64_b32 v[186:187], v181 offset0:2 offset1:3
    buffer_load_dwordx4 v2, s[28:31], s99 offen lds
    s_waitcnt vmcnt(10) lgkmcnt(11)
    s_nop 0
    v_mfma_f32_32x32x16_bf16 v[112:127], a[208:211], a[168:171], v[112:127]
    ds_read_b64_tr_b16 a[200:201], v96 offset:59392
    ds_read_b64_tr_b16 a[202:203], v96 offset:59904
    s_add_u32 m0, s54, 0
    s_nop 0
    v_mfma_f32_32x32x16_bf16 v[128:143], a[212:215], a[168:171], v[128:143]
    ds_read_b64_tr_b16 a[204:205], v97 offset:59392
    ds_read_b64_tr_b16 a[206:207], v97 offset:59904
    s_add_u32 s80, s99, 131072
    s_waitcnt vmcnt(9) lgkmcnt(11)
    s_nop 0
    v_mfma_f32_32x32x16_bf16 v[112:127], a[216:219], a[172:175], v[112:127]
    ds_read_b64_tr_b16 a[208:209], v96 offset:61440
    ds_read_b64_tr_b16 a[210:211], v96 offset:61952
    buffer_load_dwordx4 v2, s[28:31], s80 offen lds
    s_add_u32 m0, s54, 4096
    v_mfma_f32_32x32x16_bf16 v[128:143], a[220:223], a[172:175], v[128:143]
    ds_read_b64_tr_b16 a[212:213], v97 offset:61440
    ds_read_b64_tr_b16 a[214:215], v97 offset:61952
    s_add_u32 s80, s99, 262144
    s_waitcnt vmcnt(9) lgkmcnt(10)
    s_nop 0
    v_mfma_f32_32x32x16_bf16 v[112:127], a[192:195], a[176:179], v[112:127]
    ds_read_b64_tr_b16 a[216:217], v96 offset:63488
    ds_read_b64_tr_b16 a[218:219], v96 offset:64000
    buffer_load_dwordx4 v2, s[28:31], s80 offen lds
    v_mfma_f32_32x32x16_bf16 v[128:143], a[196:199], a[176:179], v[128:143]
    ds_read_b64_tr_b16 a[220:221], v97 offset:63488
    ds_read_b64_tr_b16 a[222:223], v97 offset:64000
    s_waitcnt lgkmcnt(12)
    v_add_f32 v176, v184, v185
    s_add_u32 m0, s54, 8192
    s_waitcnt vmcnt(9) lgkmcnt(8)
    v_mfma_f32_32x32x16_bf16 v[112:127], a[200:203], a[180:183], v[112:127]
    v_add_f32 v177, v186, v187
    v_add_f32_e64 v176, v176, v177
    s_add_u32 s80, s99, 393216
    v_mfma_f32_32x32x16_bf16 v[128:143], a[204:207], a[180:183], v[128:143]
    v_mul_f32 v176, 0x3b000000, v176
    buffer_load_dwordx4 v2, s[28:31], s80 offen lds
    s_add_u32 m0, s54, 12288
    s_waitcnt vmcnt(9) lgkmcnt(4)
    v_mfma_f32_32x32x16_bf16 v[112:127], a[208:211], a[184:187], v[112:127]
    v_mov_b32 v177, v176
    s_nop 1
    v_permlane32_swap_b32 v176, v177
    s_add_u32 s80, s99, 524288
    v_mfma_f32_32x32x16_bf16 v[128:143], a[212:215], a[184:187], v[128:143]
    v_fma_f32 v177, -v176, v176, v177
    v_max_f32_e64 v177, 0, v177
    buffer_load_dwordx4 v2, s[28:31], s80 offen lds
    s_waitcnt vmcnt(9) lgkmcnt(0)
    v_mfma_f32_32x32x16_bf16 v[112:127], a[216:219], a[188:191], v[112:127]
    v_add_f32 v177, 0x3727c5ac, v177
    v_rsq_f32 v177, v177
    v_mfma_f32_32x32x16_bf16 v[128:143], a[220:223], a[188:191], v[128:143]
    s_barrier
    s_cmp_lg_u32 s48, 3
    s_cbranch_scc1 Lpi29
    s_load_dword s69, s[36:37], s64 offset:0 glc
Lpi29:
    s_nop 4
    v_pk_fma_f32 v[112:113], v[192:193], v[176:177], v[112:113] op_sel:[0,0,0] op_sel_hi:[1,0,1] neg_lo:[0,1,0] neg_hi:[0,1,0]
    s_add_u32 m0, s54, 16384
    v_pk_fma_f32 v[114:115], v[194:195], v[176:177], v[114:115] op_sel:[0,0,0] op_sel_hi:[1,0,1] neg_lo:[0,1,0] neg_hi:[0,1,0]
    v_pk_fma_f32 v[116:117], v[196:197], v[176:177], v[116:117] op_sel:[0,0,0] op_sel_hi:[1,0,1] neg_lo:[0,1,0] neg_hi:[0,1,0]
    v_pk_fma_f32 v[118:119], v[198:199], v[176:177], v[118:119] op_sel:[0,0,0] op_sel_hi:[1,0,1] neg_lo:[0,1,0] neg_hi:[0,1,0]
    v_pk_fma_f32 v[120:121], v[200:201], v[176:177], v[120:121] op_sel:[0,0,0] op_sel_hi:[1,0,1] neg_lo:[0,1,0] neg_hi:[0,1,0]
    v_pk_fma_f32 v[122:123], v[202:203], v[176:177], v[122:123] op_sel:[0,0,0] op_sel_hi:[1,0,1] neg_lo:[0,1,0] neg_hi:[0,1,0]
    v_pk_fma_f32 v[124:125], v[204:205], v[176:177], v[124:125] op_sel:[0,0,0] op_sel_hi:[1,0,1] neg_lo:[0,1,0] neg_hi:[0,1,0]
    s_add_u32 s80, s99, 655360
    v_pk_fma_f32 v[126:127], v[206:207], v[176:177], v[126:127] op_sel:[0,0,0] op_sel_hi:[1,0,1] neg_lo:[0,1,0] neg_hi:[0,1,0]
    ds_read_b128 v[192:195], v107 offset:128
    ds_read_b128 v[196:199], v107 offset:144
    ds_read_b128 v[200:203], v107 offset:160
    ds_read_b128 v[204:207], v107 offset:176
    v_pk_mul_f32 v[112:113], v[112:113], v[176:177] op_sel:[0,1] op_sel_hi:[1,1]
    v_pk_mul_f32 v[114:115], v[114:115], v[176:177] op_sel:[0,1] op_sel_hi:[1,1]
    v_pk_mul_f32 v[116:117], v[116:117], v[176:177] op_sel:[0,1] op_sel_hi:[1,1]
    v_pk_mul_f32 v[118:119], v[118:119], v[176:177] op_sel:[0,1] op_sel_hi:[1,1]
    buffer_load_dwordx4 v2, s[28:31], s80 offen lds
    v_pk_mul_f32 v[120:121], v[120:121], v[176:177] op_sel:[0,1] op_sel_hi:[1,1]
    v_pk_mul_f32 v[122:123], v[122:123], v[176:177] op_sel:[0,1] op_sel_hi:[1,1]
    v_pk_mul_f32 v[124:125], v[124:125], v[176:177] op_sel:[0,1] op_sel_hi:[1,1]
    v_pk_mul_f32 v[126:127], v[126:127], v[176:177] op_sel:[0,1] op_sel_hi:[1,1]
    v_pk_mul_f32 v[208:209], v[112:113], v[112:113]
    v_pk_mul_f32 v[210:211], v[114:115], v[114:115]
    v_pk_mul_f32 v[212:213], v[116:117], v[116:117]
    v_pk_mul_f32 v[214:215], v[118:119], v[118:119]
    v_pk_mul_f32 v[216:217], v[120:121], v[120:121]
    s_add_u32 m0, s54, 20480
    v_pk_mul_f32 v[218:219], v[122:123], v[122:123]
    v_pk_mul_f32 v[220:221], v[124:125], v[124:125]
    v_pk_mul_f32 v[222:223], v[126:127], v[126:127]
    v_pk_fma_f32 v[208:209], v[208:209], s[100:101], v[40:41]
    v_pk_fma_f32 v[210:211], v[210:211], s[100:101], v[40:41]
    v_pk_fma_f32 v[212:213], v[212:213], s[100:101], v[40:41]
    v_pk_fma_f32 v[214:215], v[214:215], s[100:101], v[40:41]
    v_pk_fma_f32 v[216:217], v[216:217], s[100:101], v[40:41]
    v_pk_fma_f32 v[218:219], v[218:219], s[100:101], v[40:41]
    s_add_u32 s80, s99, 786432
    v_pk_fma_f32 v[220:221], v[220:221], s[100:101], v[40:41]
    v_pk_fma_f32 v[222:223], v[222:223], s[100:101], v[40:41]
    v_pk_mul_f32 v[208:209], v[208:209], v[112:113]
    v_pk_mul_f32 v[210:211], v[210:211], v[114:115]
    v_pk_mul_f32 v[212:213], v[212:213], v[116:117]
    v_pk_mul_f32 v[214:215], v[214:215], v[118:119]
    v_pk_mul_f32 v[216:217], v[216:217], v[120:121]
    v_pk_mul_f32 v[218:219], v[218:219], v[122:123]
    v_pk_mul_f32 v[220:221], v[220:221], v[124:125]
    buffer_load_dwordx4 v2, s[28:31], s80 offen lds
    v_pk_mul_f32 v[222:223], v[222:223], v[126:127]
    v_exp_f32 v208, v208
    v_exp_f32 v209, v209
    v_exp_f32 v210, v210
    v_exp_f32 v211, v211
    s_add_u32 m0, s54, 24576
    v_exp_f32 v212, v212
    v_exp_f32 v213, v213
    v_exp_f32 v214, v214
    v_exp_f32 v215, v215
    v_exp_f32_e64 v216, v216
    s_add_u32 s80, s99, 32768
    v_exp_f32 v217, v217
    v_exp_f32 v218, v218
    v_exp_f32 v219, v219
    v_exp_f32 v220, v220
    buffer_load_dwordx4 v2, s[28:31], s80 offen lds
    v_exp_f32 v221, v221
    v_exp_f32 v222, v222
    v_exp_f32_e64 v223, v223
    v_pk_add_f32 v[208:209], v[208:209], 1.0 op_sel_hi:[1,0]
    v_pk_add_f32 v[210:211], v[210:211], 1.0 op_sel_hi:[1,0]
    v_pk_add_f32 v[212:213], v[212:213], 1.0 op_sel_hi:[1,0]
    s_add_u32 m0, s54, 28672
    v_pk_add_f32 v[214:215], v[214:215], 1.0 op_sel_hi:[1,0]
    v_pk_add_f32 v[216:217], v[216:217], 1.0 op_sel_hi:[1,0]
    v_pk_add_f32 v[218:219], v[218:219], 1.0 op_sel_hi:[1,0]
    v_pk_add_f32 v[220:221], v[220:221], 1.0 op_sel_hi:[1,0]
    v_pk_add_f32 v[222:223], v[222:223], 1.0 op_sel_hi:[1,0]
    v_rcp_f32 v208, v208
    v_rcp_f32 v209, v209
    s_add_u32 s80, s99, 163840
    v_rcp_f32 v210, v210
    v_rcp_f32 v211, v211
    v_rcp_f32 v212, v212
    v_rcp_f32 v213, v213
    v_rcp_f32_e64 v214, v214
    buffer_load_dwordx4 v2, s[28:31], s80 offen lds
    v_rcp_f32 v215, v215
    v_rcp_f32 v216, v216
    v_rcp_f32 v217, v217
    v_rcp_f32 v218, v218
    s_add_u32 m0, s54, 32768
    v_rcp_f32 v219, v219
    v_rcp_f32 v220, v220
    v_rcp_f32 v221, v221
    v_rcp_f32 v222, v222
    v_rcp_f32_e64 v223, v223
    s_add_u32 s80, s99, 294912
    v_pk_mul_f32 v[112:113], v[112:113], v[208:209]
    v_pk_mul_f32 v[114:115], v[114:115], v[210:211]
    v_pk_mul_f32 v[116:117], v[116:117], v[212:213]
    v_pk_mul_f32 v[118:119], v[118:119], v[214:215]
    v_pk_mul_f32 v[120:121], v[120:121], v[216:217]
    v_pk_mul_f32 v[122:123], v[122:123], v[218:219]
    v_pk_mul_f32 v[124:125], v[124:125], v[220:221]
    v_pk_mul_f32 v[126:127], v[126:127], v[222:223]
    buffer_load_dwordx4 v2, s[28:31], s80 offen lds
    v_cvt_pk_bf16_f32 v224, v112, v113
    v_cvt_pk_bf16_f32 v225, v114, v115
    v_cvt_pk_bf16_f32 v226, v116, v117
    v_cvt_pk_bf16_f32 v227, v118, v119
    v_cvt_pk_bf16_f32 v228, v120, v121
    v_cvt_pk_bf16_f32 v229, v122, v123
    v_cvt_pk_bf16_f32 v230, v124, v125
    v_cvt_pk_bf16_f32 v231, v126, v127
    buffer_store_dwordx4 v[224:227], v30, s[36:39], 0 offen offset:0 sc1
    s_add_u32 m0, s54, 36864
    buffer_store_dwordx4 v[228:231], v30, s[36:39], 0 offen offset:512 sc1
    s_waitcnt lgkmcnt(0)
    s_nop 0
    s_mov_b32 s82, 2048
    v_pk_fma_f32 v[128:129], v[192:193], v[176:177], v[128:129] op_sel:[0,0,0] op_sel_hi:[1,0,1] neg_lo:[0,1,0] neg_hi:[0,1,0]
    v_pk_fma_f32 v[130:131], v[194:195], v[176:177], v[130:131] op_sel:[0,0,0] op_sel_hi:[1,0,1] neg_lo:[0,1,0] neg_hi:[0,1,0]
    v_pk_fma_f32 v[132:133], v[196:197], v[176:177], v[132:133] op_sel:[0,0,0] op_sel_hi:[1,0,1] neg_lo:[0,1,0] neg_hi:[0,1,0]
    v_pk_fma_f32 v[134:135], v[198:199], v[176:177], v[134:135] op_sel:[0,0,0] op_sel_hi:[1,0,1] neg_lo:[0,1,0] neg_hi:[0,1,0]
    v_pk_fma_f32 v[136:137], v[200:201], v[176:177], v[136:137] op_sel:[0,0,0] op_sel_hi:[1,0,1] neg_lo:[0,1,0] neg_hi:[0,1,0]
    v_pk_fma_f32 v[138:139], v[202:203], v[176:177], v[138:139] op_sel:[0,0,0] op_sel_hi:[1,0,1] neg_lo:[0,1,0] neg_hi:[0,1,0]
    s_add_u32 s80, s99, 425984
    v_pk_fma_f32 v[140:141], v[204:205], v[176:177], v[140:141] op_sel:[0,0,0] op_sel_hi:[1,0,1] neg_lo:[0,1,0] neg_hi:[0,1,0]
    v_pk_fma_f32 v[142:143], v[206:207], v[176:177], v[142:143] op_sel:[0,0,0] op_sel_hi:[1,0,1] neg_lo:[0,1,0] neg_hi:[0,1,0]
    ds_read_b128 v[192:195], v107 offset:256
    ds_read_b128 v[196:199], v107 offset:272
    ds_read_b128 v[200:203], v107 offset:288
    ds_read_b128 v[204:207], v107 offset:304
    v_pk_mul_f32 v[128:129], v[128:129], v[176:177] op_sel:[0,1] op_sel_hi:[1,1]
    v_pk_mul_f32 v[130:131], v[130:131], v[176:177] op_sel:[0,1] op_sel_hi:[1,1]
    v_pk_mul_f32 v[132:133], v[132:133], v[176:177] op_sel:[0,1] op_sel_hi:[1,1]
    buffer_load_dwordx4 v2, s[28:31], s80 offen lds
    v_pk_mul_f32 v[134:135], v[134:135], v[176:177] op_sel:[0,1] op_sel_hi:[1,1]
    v_pk_mul_f32 v[136:137], v[136:137], v[176:177] op_sel:[0,1] op_sel_hi:[1,1]
    v_pk_mul_f32 v[138:139], v[138:139], v[176:177] op_sel:[0,1] op_sel_hi:[1,1]
    v_pk_mul_f32 v[140:141], v[140:141], v[176:177] op_sel:[0,1] op_sel_hi:[1,1]
    v_pk_mul_f32 v[142:143], v[142:143], v[176:177] op_sel:[0,1] op_sel_hi:[1,1]
    v_pk_mul_f32 v[208:209], v[128:129], v[128:129]
    v_pk_mul_f32 v[210:211], v[130:131], v[130:131]
    v_pk_mul_f32 v[212:213], v[132:133], v[132:133]
    v_pk_mul_f32 v[214:215], v[134:135], v[134:135]
    v_add_u32 v98, 81920, v96
    v_add_u32 v99, 81920, v97
    ds_read_b64_tr_b16 a[192:193], v98 offset:0
    ds_read_b64_tr_b16 a[194:195], v98 offset:512
    ds_read_b64_tr_b16 a[196:197], v98 offset:2048
    ds_read_b64_tr_b16 a[198:199], v98 offset:2560
    ds_read_b64_tr_b16 a[200:201], v98 offset:4096
    ds_read_b64_tr_b16 a[202:203], v98 offset:4608
    ds_read_b64_tr_b16 a[204:205], v98 offset:6144
    ds_read_b64_tr_b16 a[206:207], v98 offset:6656
    ds_read_b64_tr_b16 a[208:209], v98 offset:8192
    ds_read_b64_tr_b16 a[210:211], v98 offset:8704
    ds_read_b64_tr_b16 a[212:213], v98 offset:10240
    ds_read_b64_tr_b16 a[214:215], v98 offset:10752
    v_pk_mul_f32 v[216:217], v[136:137], v[136:137]
    v_pk_mul_f32 v[218:219], v[138:139], v[138:139]
    v_pk_mul_f32 v[220:221], v[140:141], v[140:141]
    v_pk_mul_f32 v[222:223], v[142:143], v[142:143]
    v_pk_fma_f32 v[208:209], v[208:209], s[100:101], v[40:41]
    v_pk_fma_f32 v[210:211], v[210:211], s[100:101], v[40:41]
    v_pk_fma_f32 v[212:213], v[212:213], s[100:101], v[40:41]
    v_pk_fma_f32 v[214:215], v[214:215], s[100:101], v[40:41]
    v_pk_fma_f32 v[216:217], v[216:217], s[100:101], v[40:41]
    v_pk_fma_f32 v[218:219], v[218:219], s[100:101], v[40:41]
    v_pk_fma_f32 v[220:221], v[220:221], s[100:101], v[40:41]
    v_pk_fma_f32 v[222:223], v[222:223], s[100:101], v[40:41]
    v_pk_mul_f32 v[208:209], v[208:209], v[128:129]
    v_pk_mul_f32 v[210:211], v[210:211], v[130:131]
    v_pk_mul_f32 v[212:213], v[212:213], v[132:133]
    v_pk_mul_f32 v[214:215], v[214:215], v[134:135]
    v_pk_mul_f32 v[216:217], v[216:217], v[136:137]
    v_pk_mul_f32 v[218:219], v[218:219], v[138:139]
    v_pk_mul_f32 v[220:221], v[220:221], v[140:141]
    v_pk_mul_f32 v[222:223], v[222:223], v[142:143]
    s_cmp_lg_u32 s48, 3
    s_cbranch_scc1 Lpolld31
    s_waitcnt lgkmcnt(0)
    s_cmp_lt_u32 s69, 8
    s_cbranch_scc1 Lpoll30
Lpolld31:
    s_barrier
    s_waitcnt lgkmcnt(8)
    s_nop 0
    v_mfma_f32_32x32x16_bf16 v[144:159], a[192:195], a[64:67], 0
    ds_read_b64_tr_b16 a[216:217], v98 offset:12288
    ds_read_b64_tr_b16 a[218:219], v98 offset:12800
    v_exp_f32_e64 v208, v208
    s_add_u32 m0, s54, 147456
    s_add_u32 s80, s99, 557056
    v_mfma_f32_32x32x16_bf16 v[144:159], a[196:199], a[68:71], v[144:159]
    ds_read_b64_tr_b16 a[220:221], v98 offset:14336
    ds_read_b64_tr_b16 a[222:223], v98 offset:14848
    v_exp_f32 v209, v209
    v_exp_f32 v210, v210
    buffer_load_dwordx4 v2, s[28:31], s80 offen lds
    s_waitcnt lgkmcnt(8)
    s_nop 0
    v_mfma_f32_32x32x16_bf16 v[144:159], a[200:203], a[72:75], v[144:159]
    ds_read_b64_tr_b16 a[192:193], v98 offset:16384
    ds_read_b64_tr_b16 a[194:195], v98 offset:16896
    v_exp_f32 v211, v211
    v_exp_f32 v212, v212
    s_mov_b32 s98, 2097152
    v_mfma_f32_32x32x16_bf16 v[144:159], a[204:207], a[76:79], v[144:159]
    ds_read_b64_tr_b16 a[196:197], v98 offset:18432
    ds_read_b64_tr_b16 a[198:199], v98 offset:18944
    v_exp_f32_e64 v213, v213
    buffer_load_dwordx4 a[0:3], v20, s[36:39], s98 offen offset:0 sc1
    s_waitcnt lgkmcnt(8)
    s_nop 0
    v_mfma_f32_32x32x16_bf16 v[144:159], a[208:211], a[80:83], v[144:159]
    ds_read_b64_tr_b16 a[200:201], v98 offset:20480
    ds_read_b64_tr_b16 a[202:203], v98 offset:20992
    v_exp_f32 v214, v214
    v_exp_f32 v215, v215
    v_add_f32_e64 v208, 1.0, v208
    s_add_u32 m0, s54, 40960
    v_mfma_f32_32x32x16_bf16 v[144:159], a[212:215], a[84:87], v[144:159]
    ds_read_b64_tr_b16 a[204:205], v98 offset:22528
    ds_read_b64_tr_b16 a[206:207], v98 offset:23040
    v_add_f32 v209, 1.0, v209
    v_add_f32 v210, 1.0, v210
    v_add_f32_e64 v211, 1.0, v211
    s_add_u32 s80, s99, 688128
    s_waitcnt lgkmcnt(8)
    s_nop 0
    v_mfma_f32_32x32x16_bf16 v[144:159], a[216:219], a[88:91], v[144:159]
    ds_read_b64_tr_b16 a[208:209], v98 offset:24576
    ds_read_b64_tr_b16 a[210:211], v98 offset:25088
    v_add_f32 v212, 1.0, v212
    v_add_f32 v213, 1.0, v213
    v_add_f32_e64 v214, 1.0, v214
    buffer_load_dwordx4 v2, s[28:31], s80 offen lds
    v_mfma_f32_32x32x16_bf16 v[144:159], a[220:223], a[92:95], v[144:159]
    ds_read_b64_tr_b16 a[212:213], v98 offset:26624
    ds_read_b64_tr_b16 a[214:215], v98 offset:27136
    v_add_f32 v215, 1.0, v215
    v_rcp_f32 v208, v208
    buffer_load_dwordx4 a[4:7], v21, s[36:39], s98 offen offset:0 sc1
    s_waitcnt lgkmcnt(8)
    s_nop 0
    v_mfma_f32_32x32x16_bf16 v[144:159], a[192:195], a[96:99], v[144:159]
    ds_read_b64_tr_b16 a[216:217], v98 offset:28672
    ds_read_b64_tr_b16 a[218:219], v98 offset:29184
    v_rcp_f32 v209, v209
    v_rcp_f32 v210, v210
    v_mfma_f32_32x32x16_bf16 v[144:159], a[196:199], a[100:103], v[144:159]
    ds_read_b64_tr_b16 a[220:221], v98 offset:30720
    ds_read_b64_tr_b16 a[222:223], v98 offset:31232
    v_rcp_f32 v211, v211
    v_rcp_f32 v212, v212
    s_add_u32 m0, s54, 45056
    s_add_u32 s80, s99, 819200
    s_waitcnt lgkmcnt(8)
    s_nop 0
    v_mfma_f32_32x32x16_bf16 v[144:159], a[200:203], a[104:107], v[144:159]
    ds_read_b64_tr_b16 a[192:193], v98 offset:32768
    ds_read_b64_tr_b16 a[194:195], v98 offset:33280
    v_rcp_f32_e64 v213, v213
    buffer_load_dwordx4 v2, s[28:31], s80 offen lds
    v_mfma_f32_32x32x16_bf16 v[144:159], a[204:207], a[108:111], v[144:159]
    ds_read_b64_tr_b16 a[196:197], v98 offset:34816
    ds_read_b64_tr_b16 a[198:199], v98 offset:35328
    v_rcp_f32 v214, v214
    v_rcp_f32 v215, v215
    s_waitcnt lgkmcnt(8)
    s_nop 0
    v_mfma_f32_32x32x16_bf16 v[144:159], a[208:211], a[112:115], v[144:159]
    ds_read_b64_tr_b16 a[200:201], v98 offset:36864
    ds_read_b64_tr_b16 a[202:203], v98 offset:37376
    v_mul_f32 v128, v128, v208
    v_mul_f32 v129, v129, v209
    v_mul_f32 v130, v130, v210
    v_mul_f32 v131, v131, v211
    buffer_load_dwordx4 a[8:11], v20, s[36:39], s98 offen offset:2048 sc1
    v_mfma_f32_32x32x16_bf16 v[144:159], a[212:215], a[116:119], v[144:159]
    ds_read_b64_tr_b16 a[204:205], v98 offset:38912
    ds_read_b64_tr_b16 a[206:207], v98 offset:39424
    v_mul_f32 v132, v132, v212
    v_mul_f32 v133, v133, v213
    v_mul_f32 v134, v134, v214
    s_waitcnt lgkmcnt(8)
    v_mfma_f32_32x32x16_bf16 v[144:159], a[216:219], a[120:123], v[144:159]
    ds_read_b64_tr_b16 a[208:209], v98 offset:40960
    ds_read_b64_tr_b16 a[210:211], v98 offset:41472
    v_mul_f32_e64 v135, v135, v215
    v_cvt_pk_bf16_f32 v232, v128, v129
    v_cvt_pk_bf16_f32 v233, v130, v131
    v_cvt_pk_bf16_f32 v234, v132, v133
    buffer_load_dwordx4 a[12:15], v21, s[36:39], s98 offen offset:2048 sc1
    v_mfma_f32_32x32x16_bf16 v[144:159], a[220:223], a[124:127], v[144:159]
    ds_read_b64_tr_b16 a[212:213], v98 offset:43008
    ds_read_b64_tr_b16 a[214:215], v98 offset:43520
    v_cvt_pk_bf16_f32 v235, v134, v135
    buffer_store_dwordx4 v[232:235], v30, s[36:39], s82 offen offset:0 sc1
    s_waitcnt vmcnt(9)
    s_barrier
    s_waitcnt lgkmcnt(8)
    s_nop 0
    v_mfma_f32_32x32x16_bf16 v[144:159], a[192:195], a[128:131], v[144:159]
    ds_read_b64_tr_b16 a[216:217], v98 offset:45056
    ds_read_b64_tr_b16 a[218:219], v98 offset:45568
    v_exp_f32 v216, v216
    s_cmp_lg_u32 s0, 0
    s_cbranch_scc1 Lsg32
    s_atomic_add s1, s[36:37], s67 offset:128
Lsg32:
    s_mov_b32 s98, 2101248
    v_mfma_f32_32x32x16_bf16 v[144:159], a[196:199], a[132:135], v[144:159]
    ds_read_b64_tr_b16 a[220:221], v98 offset:47104
    ds_read_b64_tr_b16 a[222:223], v98 offset:47616
    v_exp_f32 v217, v217
    v_exp_f32_e64 v218, v218
    buffer_load_dwordx4 a[16:19], v20, s[36:39], s98 offen offset:0 sc1
    s_waitcnt lgkmcnt(8)
    s_nop 0
    v_mfma_f32_32x32x16_bf16 v[144:159], a[200:203], a[136:139], v[144:159]
    ds_read_b64_tr_b16 a[192:193], v98 offset:49152
    ds_read_b64_tr_b16 a[194:195], v98 offset:49664
    v_exp_f32 v219, v219
    v_exp_f32 v220, v220
    v_mfma_f32_32x32x16_bf16 v[144:159], a[204:207], a[140:143], v[144:159]
    ds_read_b64_tr_b16 a[196:197], v98 offset:51200
    ds_read_b64_tr_b16 a[198:199], v98 offset:51712
    v_exp_f32_e64 v221, v221
    buffer_load_dwordx4 a[20:23], v21, s[36:39], s98 offen offset:0 sc1
    s_waitcnt lgkmcnt(8)
    s_nop 0
    v_mfma_f32_32x32x16_bf16 v[144:159], a[208:211], a[144:147], v[144:159]
    ds_read_b64_tr_b16 a[200:201], v98 offset:53248
    ds_read_b64_tr_b16 a[202:203], v98 offset:53760
    v_exp_f32 v222, v222
    v_exp_f32 v223, v223
    v_add_f32_e64 v216, 1.0, v216
    v_mfma_f32_32x32x16_bf16 v[144:159], a[212:215], a[148:151], v[144:159]
    ds_read_b64_tr_b16 a[204:205], v98 offset:55296
    ds_read_b64_tr_b16 a[206:207], v98 offset:55808
    v_add_f32 v217, 1.0, v217
    v_add_f32 v218, 1.0, v218
    v_add_f32_e64 v219, 1.0, v219
    buffer_load_dwordx4 a[24:27], v20, s[36:39], s98 offen offset:2048 sc1
    s_waitcnt lgkmcnt(8)
    s_nop 0
    v_mfma_f32_32x32x16_bf16 v[144:159], a[216:219], a[152:155], v[144:159]
    ds_read_b64_tr_b16 a[208:209], v98 offset:57344
    ds_read_b64_tr_b16 a[210:211], v98 offset:57856
    v_add_f32 v220, 1.0, v220
    v_add_f32 v221, 1.0, v221
    v_add_f32_e64 v222, 1.0, v222
    v_mfma_f32_32x32x16_bf16 v[144:159], a[220:223], a[156:159], v[144:159]
    ds_read_b64_tr_b16 a[212:213], v98 offset:59392
    ds_read_b64_tr_b16 a[214:215], v98 offset:59904
    v_add_f32 v223, 1.0, v223
    v_rcp_f32 v216, v216
    s_waitcnt lgkmcnt(8)
    s_nop 0
    v_mfma_f32_32x32x16_bf16 v[144:159], a[192:195], a[160:163], v[144:159]
    ds_read_b64_tr_b16 a[216:217], v98 offset:61440
    ds_read_b64_tr_b16 a[218:219], v98 offset:61952
    v_rcp_f32 v217, v217
    v_rcp_f32 v218, v218
    buffer_load_dwordx4 a[28:31], v21, s[36:39], s98 offen offset:2048 sc1
    v_mfma_f32_32x32x16_bf16 v[144:159], a[196:199], a[164:167], v[144:159]
    ds_read_b64_tr_b16 a[220:221], v98 offset:63488
    ds_read_b64_tr_b16 a[222:223], v98 offset:64000
    v_rcp_f32_e64 v219, v219
    s_add_u32 m0, s54, 49152
    s_mov_b32 s80, 65536
    s_waitcnt lgkmcnt(8)
    v_mfma_f32_32x32x16_bf16 v[144:159], a[200:203], a[168:171], v[144:159]
    v_rcp_f32 v220, v220
    v_rcp_f32_e64 v221, v221
    buffer_load_dwordx4 v2, s[28:31], s80 offen lds
    v_mfma_f32_32x32x16_bf16 v[144:159], a[204:207], a[172:175], v[144:159]
    v_rcp_f32 v222, v222
    v_rcp_f32 v223, v223
    s_add_u32 m0, s54, 53248
    s_waitcnt lgkmcnt(4)
    v_mfma_f32_32x32x16_bf16 v[144:159], a[208:211], a[176:179], v[144:159]
    v_mul_f32 v136, v136, v216
    v_mul_f32 v137, v137, v217
    v_mul_f32 v138, v138, v218
    s_mov_b32 s80, 196608
    buffer_load_dwordx4 v2, s[28:31], s80 offen lds
    v_mfma_f32_32x32x16_bf16 v[144:159], a[212:215], a[180:183], v[144:159]
    v_mul_f32 v139, v139, v219
    v_mul_f32 v140, v140, v220
    v_mul_f32 v141, v141, v221
    v_mul_f32 v142, v142, v222
    s_add_u32 m0, s54, 57344
    s_waitcnt lgkmcnt(0)
    v_mfma_f32_32x32x16_bf16 v[144:159], a[216:219], a[184:187], v[144:159]
    v_mul_f32 v143, v143, v223
    v_cvt_pk_bf16_f32 v236, v136, v137
    v_cvt_pk_bf16_f32 v237, v138, v139
    s_mov_b32 s80, 327680
    v_mfma_f32_32x32x16_bf16 v[144:159], a[220:223], a[188:191], v[144:159]
    v_cvt_pk_bf16_f32 v238, v140, v141
    v_cvt_pk_bf16_f32 v239, v142, v143
    buffer_store_dwordx4 v[236:239], v30, s[36:39], s82 offen offset:512 sc1
    buffer_load_dwordx4 v2, s[28:31], s80 offen lds
    ds_read_b64_tr_b16 a[192:193], v99 offset:0
    ds_read_b64_tr_b16 a[194:195], v99 offset:512
    ds_read_b64_tr_b16 a[196:197], v99 offset:2048
    ds_read_b64_tr_b16 a[198:199], v99 offset:2560
    ds_read_b64_tr_b16 a[200:201], v99 offset:4096
    ds_read_b64_tr_b16 a[202:203], v99 offset:4608
    ds_read_b64_tr_b16 a[204:205], v99 offset:6144
    ds_read_b64_tr_b16 a[206:207], v99 offset:6656
    ds_read_b64_tr_b16 a[208:209], v99 offset:8192
    ds_read_b64_tr_b16 a[210:211], v99 offset:8704
    ds_read_b64_tr_b16 a[212:213], v99 offset:10240
    ds_read_b64_tr_b16 a[214:215], v99 offset:10752
    s_mov_b32 s82, 10485760
    v_pk_fma_f32 v[144:145], v[192:193], v[176:177], v[144:145] op_sel:[0,0,0] op_sel_hi:[1,0,1] neg_lo:[0,1,0] neg_hi:[0,1,0]
    v_pk_fma_f32 v[146:147], v[194:195], v[176:177], v[146:147] op_sel:[0,0,0] op_sel_hi:[1,0,1] neg_lo:[0,1,0] neg_hi:[0,1,0]
    v_pk_fma_f32 v[148:149], v[196:197], v[176:177], v[148:149] op_sel:[0,0,0] op_sel_hi:[1,0,1] neg_lo:[0,1,0] neg_hi:[0,1,0]
    v_pk_fma_f32 v[150:151], v[198:199], v[176:177], v[150:151] op_sel:[0,0,0] op_sel_hi:[1,0,1] neg_lo:[0,1,0] neg_hi:[0,1,0]
    v_pk_fma_f32 v[152:153], v[200:201], v[176:177], v[152:153] op_sel:[0,0,0] op_sel_hi:[1,0,1] neg_lo:[0,1,0] neg_hi:[0,1,0]
    v_pk_fma_f32 v[154:155], v[202:203], v[176:177], v[154:155] op_sel:[0,0,0] op_sel_hi:[1,0,1] neg_lo:[0,1,0] neg_hi:[0,1,0]
    v_pk_fma_f32 v[156:157], v[204:205], v[176:177], v[156:157] op_sel:[0,0,0] op_sel_hi:[1,0,1] neg_lo:[0,1,0] neg_hi:[0,1,0]
    v_pk_fma_f32 v[158:159], v[206:207], v[176:177], v[158:159] op_sel:[0,0,0] op_sel_hi:[1,0,1] neg_lo:[0,1,0] neg_hi:[0,1,0]
    ds_read_b128 v[192:195], v107 offset:384
    ds_read_b128 v[196:199], v107 offset:400
    ds_read_b128 v[200:203], v107 offset:416
    ds_read_b128 v[204:207], v107 offset:432
    v_pk_mul_f32 v[144:145], v[144:145], v[176:177] op_sel:[0,1] op_sel_hi:[1,1]
    v_pk_mul_f32 v[146:147], v[146:147], v[176:177] op_sel:[0,1] op_sel_hi:[1,1]
    v_pk_mul_f32 v[148:149], v[148:149], v[176:177] op_sel:[0,1] op_sel_hi:[1,1]
    v_pk_mul_f32 v[150:151], v[150:151], v[176:177] op_sel:[0,1] op_sel_hi:[1,1]
    v_pk_mul_f32 v[152:153], v[152:153], v[176:177] op_sel:[0,1] op_sel_hi:[1,1]
    v_pk_mul_f32 v[154:155], v[154:155], v[176:177] op_sel:[0,1] op_sel_hi:[1,1]
    v_pk_mul_f32 v[156:157], v[156:157], v[176:177] op_sel:[0,1] op_sel_hi:[1,1]
    v_pk_mul_f32 v[158:159], v[158:159], v[176:177] op_sel:[0,1] op_sel_hi:[1,1]
    v_pk_mul_f32 v[208:209], v[144:145], v[144:145]
    v_pk_mul_f32 v[210:211], v[146:147], v[146:147]
    v_pk_mul_f32 v[212:213], v[148:149], v[148:149]
    v_pk_mul_f32 v[214:215], v[150:151], v[150:151]
    v_pk_mul_f32 v[216:217], v[152:153], v[152:153]
    v_pk_mul_f32 v[218:219], v[154:155], v[154:155]
    v_pk_mul_f32 v[220:221], v[156:157], v[156:157]
    v_pk_mul_f32 v[222:223], v[158:159], v[158:159]
    v_pk_fma_f32 v[208:209], v[208:209], s[100:101], v[40:41]
    v_pk_fma_f32 v[210:211], v[210:211], s[100:101], v[40:41]
    v_pk_fma_f32 v[212:213], v[212:213], s[100:101], v[40:41]
    v_pk_fma_f32 v[214:215], v[214:215], s[100:101], v[40:41]
    v_pk_fma_f32 v[216:217], v[216:217], s[100:101], v[40:41]
    v_pk_fma_f32 v[218:219], v[218:219], s[100:101], v[40:41]
    v_pk_fma_f32 v[220:221], v[220:221], s[100:101], v[40:41]
    v_pk_fma_f32 v[222:223], v[222:223], s[100:101], v[40:41]
    v_pk_mul_f32 v[208:209], v[208:209], v[144:145]
    v_pk_mul_f32 v[210:211], v[210:211], v[146:147]
    v_pk_mul_f32 v[212:213], v[212:213], v[148:149]
    v_pk_mul_f32 v[214:215], v[214:215], v[150:151]
    v_pk_mul_f32 v[216:217], v[216:217], v[152:153]
    v_pk_mul_f32 v[218:219], v[218:219], v[154:155]
    v_pk_mul_f32 v[220:221], v[220:221], v[156:157]
    v_pk_mul_f32 v[222:223], v[222:223], v[158:159]
    s_waitcnt lgkmcnt(12)
    s_nop 0
    v_mfma_f32_32x32x16_bf16 v[160:175], a[192:195], a[64:67], 0
    ds_read_b64_tr_b16 a[216:217], v99 offset:12288
    ds_read_b64_tr_b16 a[218:219], v99 offset:12800
    v_exp_f32_e64 v208, v208
    s_add_u32 m0, s54, 61440
    s_mov_b32 s80, 458752
    v_mfma_f32_32x32x16_bf16 v[160:175], a[196:199], a[68:71], v[160:175]
    ds_read_b64_tr_b16 a[220:221], v99 offset:14336
    ds_read_b64_tr_b16 a[222:223], v99 offset:14848
    v_exp_f32 v209, v209
    v_exp_f32 v210, v210
    buffer_load_dwordx4 v2, s[28:31], s80 offen lds
    s_waitcnt lgkmcnt(12)
    s_nop 0
    v_mfma_f32_32x32x16_bf16 v[160:175], a[200:203], a[72:75], v[160:175]
    ds_read_b64_tr_b16 a[192:193], v99 offset:16384
    ds_read_b64_tr_b16 a[194:195], v99 offset:16896
    v_exp_f32 v211, v211
    v_exp_f32 v212, v212
    s_mov_b32 s80, 589824
    v_mfma_f32_32x32x16_bf16 v[160:175], a[204:207], a[76:79], v[160:175]
    ds_read_b64_tr_b16 a[196:197], v99 offset:18432
    ds_read_b64_tr_b16 a[198:199], v99 offset:18944
    v_exp_f32_e64 v213, v213
    buffer_load_dwordx4 v[112:115], v2, s[28:31], s80 offen
    s_waitcnt lgkmcnt(12)
    s_nop 0
    v_mfma_f32_32x32x16_bf16 v[160:175], a[208:211], a[80:83], v[160:175]
    ds_read_b64_tr_b16 a[200:201], v99 offset:20480
    ds_read_b64_tr_b16 a[202:203], v99 offset:20992
    v_exp_f32 v214, v214
    v_exp_f32 v215, v215
    v_add_f32_e64 v208, 1.0, v208
    s_mov_b32 s80, 720896
    v_mfma_f32_32x32x16_bf16 v[160:175], a[212:215], a[84:87], v[160:175]
    ds_read_b64_tr_b16 a[204:205], v99 offset:22528
    ds_read_b64_tr_b16 a[206:207], v99 offset:23040
    v_add_f32 v209, 1.0, v209
    v_add_f32 v210, 1.0, v210
    v_add_f32_e64 v211, 1.0, v211
    buffer_load_dwordx4 v[116:119], v2, s[28:31], s80 offen
    s_waitcnt lgkmcnt(8)
    s_nop 0
    v_mfma_f32_32x32x16_bf16 v[160:175], a[216:219], a[88:91], v[160:175]
    ds_read_b64_tr_b16 a[208:209], v99 offset:24576
    ds_read_b64_tr_b16 a[210:211], v99 offset:25088
    v_add_f32 v212, 1.0, v212
    v_add_f32 v213, 1.0, v213
    v_add_f32_e64 v214, 1.0, v214
    s_mov_b32 s80, 851968
    v_mfma_f32_32x32x16_bf16 v[160:175], a[220:223], a[92:95], v[160:175]
    ds_read_b64_tr_b16 a[212:213], v99 offset:26624
    ds_read_b64_tr_b16 a[214:215], v99 offset:27136
    v_add_f32 v215, 1.0, v215
    v_rcp_f32 v208, v208
    buffer_load_dwordx4 v[120:123], v2, s[28:31], s80 offen
    s_waitcnt lgkmcnt(8)
    s_nop 0
    v_mfma_f32_32x32x16_bf16 v[160:175], a[192:195], a[96:99], v[160:175]
    ds_read_b64_tr_b16 a[216:217], v99 offset:28672
    ds_read_b64_tr_b16 a[218:219], v99 offset:29184
    v_rcp_f32 v209, v209
    v_rcp_f32 v210, v210
    v_mfma_f32_32x32x16_bf16 v[160:175], a[196:199], a[100:103], v[160:175]
    ds_read_b64_tr_b16 a[220:221], v99 offset:30720
    ds_read_b64_tr_b16 a[222:223], v99 offset:31232
    v_rcp_f32 v211, v211
    v_rcp_f32 v212, v212
    s_mov_b32 s80, 983040
    s_waitcnt lgkmcnt(8)
    s_nop 0
    v_mfma_f32_32x32x16_bf16 v[160:175], a[200:203], a[104:107], v[160:175]
    ds_read_b64_tr_b16 a[192:193], v99 offset:32768
    ds_read_b64_tr_b16 a[194:195], v99 offset:33280
    v_rcp_f32_e64 v213, v213
    buffer_load_dwordx4 v[124:127], v2, s[28:31], s80 offen
    v_mfma_f32_32x32x16_bf16 v[160:175], a[204:207], a[108:111], v[160:175]
    ds_read_b64_tr_b16 a[196:197], v99 offset:34816
    ds_read_b64_tr_b16 a[198:199], v99 offset:35328
    v_rcp_f32 v214, v214
    v_rcp_f32 v215, v215
    s_waitcnt lgkmcnt(8)
    s_nop 0
    v_mfma_f32_32x32x16_bf16 v[160:175], a[208:211], a[112:115], v[160:175]
    ds_read_b64_tr_b16 a[200:201], v99 offset:36864
    ds_read_b64_tr_b16 a[202:203], v99 offset:37376
    v_mul_f32 v144, v144, v208
    v_mul_f32 v145, v145, v209
    v_mul_f32 v146, v146, v210
    v_mul_f32 v147, v147, v211
    v_mfma_f32_32x32x16_bf16 v[160:175], a[212:215], a[116:119], v[160:175]
    ds_read_b64_tr_b16 a[204:205], v99 offset:38912
    ds_read_b64_tr_b16 a[206:207], v99 offset:39424
    v_mul_f32 v148, v148, v212
    v_mul_f32 v149, v149, v213
    v_mul_f32 v150, v150, v214
    s_waitcnt lgkmcnt(8)
    v_mfma_f32_32x32x16_bf16 v[160:175], a[216:219], a[120:123], v[160:175]
    ds_read_b64_tr_b16 a[208:209], v99 offset:40960
    ds_read_b64_tr_b16 a[210:211], v99 offset:41472
    v_mul_f32_e64 v151, v151, v215
    v_cvt_pk_bf16_f32 v224, v144, v145
    v_cvt_pk_bf16_f32 v225, v146, v147
    v_cvt_pk_bf16_f32 v226, v148, v149
    v_mfma_f32_32x32x16_bf16 v[160:175], a[220:223], a[124:127], v[160:175]
    ds_read_b64_tr_b16 a[212:213], v99 offset:43008
    ds_read_b64_tr_b16 a[214:215], v99 offset:43520
    v_cvt_pk_bf16_f32 v227, v150, v151
    buffer_store_dwordx4 v[224:227], v31, s[36:39], s82 offen offset:0 sc1
    s_barrier
    s_waitcnt lgkmcnt(8)
    v_mfma_f32_32x32x16_bf16 v[160:175], a[192:195], a[128:131], v[160:175]
    ds_read_b64_tr_b16 a[216:217], v99 offset:45056
    ds_read_b64_tr_b16 a[218:219], v99 offset:45568
    v_exp_f32 v216, v216
    s_cmp_lg_u32 s48, 3
    s_cbranch_scc1 Lpi33
    s_load_dword s69, s[36:37], s64 offset:128 glc
Lpi33:
    s_add_u32 m0, s54, 81920
    s_mov_b32 s80, 1114112
    v_mfma_f32_32x32x16_bf16 v[160:175], a[196:199], a[132:135], v[160:175]
    ds_read_b64_tr_b16 a[220:221], v99 offset:47104
    ds_read_b64_tr_b16 a[222:223], v99 offset:47616
    v_exp_f32 v217, v217
    v_exp_f32_e64 v218, v218
    buffer_load_dwordx4 v2, s[28:31], s80 offen lds
    s_waitcnt lgkmcnt(8)
    s_nop 0
    v_mfma_f32_32x32x16_bf16 v[160:175], a[200:203], a[136:139], v[160:175]
    ds_read_b64_tr_b16 a[192:193], v99 offset:49152
    ds_read_b64_tr_b16 a[194:195], v99 offset:49664
    v_exp_f32 v219, v219
    v_exp_f32 v220, v220
    s_add_u32 m0, s54, 86016
    v_mfma_f32_32x32x16_bf16 v[160:175], a[204:207], a[140:143], v[160:175]
    ds_read_b64_tr_b16 a[196:197], v99 offset:51200
    ds_read_b64_tr_b16 a[198:199], v99 offset:51712
    v_exp_f32_e64 v221, v221
    s_mov_b32 s80, 1245184
    buffer_load_dwordx4 v2, s[28:31], s80 offen lds
    s_waitcnt lgkmcnt(8)
    s_nop 0
    v_mfma_f32_32x32x16_bf16 v[160:175], a[208:211], a[144:147], v[160:175]
    ds_read_b64_tr_b16 a[200:201], v99 offset:53248
    ds_read_b64_tr_b16 a[202:203], v99 offset:53760
    v_exp_f32 v222, v222
    v_exp_f32 v223, v223
    v_add_f32_e64 v216, 1.0, v216
    s_add_u32 m0, s54, 90112
    v_mfma_f32_32x32x16_bf16 v[160:175], a[212:215], a[148:151], v[160:175]
    ds_read_b64_tr_b16 a[204:205], v99 offset:55296
    ds_read_b64_tr_b16 a[206:207], v99 offset:55808
    v_add_f32 v217, 1.0, v217
    v_add_f32 v218, 1.0, v218
    v_add_f32_e64 v219, 1.0, v219
    s_mov_b32 s80, 1376256
    s_waitcnt lgkmcnt(8)
    s_nop 0
    v_mfma_f32_32x32x16_bf16 v[160:175], a[216:219], a[152:155], v[160:175]
    ds_read_b64_tr_b16 a[208:209], v99 offset:57344
    ds_read_b64_tr_b16 a[210:211], v99 offset:57856
    v_add_f32 v220, 1.0, v220
    v_add_f32 v221, 1.0, v221
    v_add_f32_e64 v222, 1.0, v222
    buffer_load_dwordx4 v2, s[28:31], s80 offen lds
    s_add_u32 m0, s54, 94208
    v_mfma_f32_32x32x16_bf16 v[160:175], a[220:223], a[156:159], v[160:175]
    ds_read_b64_tr_b16 a[212:213], v99 offset:59392
    ds_read_b64_tr_b16 a[214:215], v99 offset:59904
    v_add_f32 v223, 1.0, v223
    v_rcp_f32 v216, v216
    s_mov_b32 s80, 1507328
    s_waitcnt lgkmcnt(8)
    s_nop 0
    v_mfma_f32_32x32x16_bf16 v[160:175], a[192:195], a[160:163], v[160:175]
    ds_read_b64_tr_b16 a[216:217], v99 offset:61440
    ds_read_b64_tr_b16 a[218:219], v99 offset:61952
    v_rcp_f32 v217, v217
    v_rcp_f32 v218, v218
    buffer_load_dwordx4 v2, s[28:31], s80 offen lds
    v_mfma_f32_32x32x16_bf16 v[160:175], a[196:199], a[164:167], v[160:175]
    ds_read_b64_tr_b16 a[220:221], v99 offset:63488
    ds_read_b64_tr_b16 a[222:223], v99 offset:64000
    v_rcp_f32_e64 v219, v219
    s_add_u32 m0, s54, 98304
    s_mov_b32 s80, 1638400
    s_waitcnt lgkmcnt(8)
    v_mfma_f32_32x32x16_bf16 v[160:175], a[200:203], a[168:171], v[160:175]
    v_rcp_f32 v220, v220
    v_rcp_f32_e64 v221, v221
    buffer_load_dwordx4 v2, s[28:31], s80 offen lds
    v_mfma_f32_32x32x16_bf16 v[160:175], a[204:207], a[172:175], v[160:175]
    v_rcp_f32 v222, v222
    v_rcp_f32 v223, v223
    s_add_u32 m0, s54, 102400
    s_waitcnt lgkmcnt(4)
    v_mfma_f32_32x32x16_bf16 v[160:175], a[208:211], a[176:179], v[160:175]
    v_mul_f32 v152, v152, v216
    v_mul_f32 v153, v153, v217
    v_mul_f32 v154, v154, v218
    s_mov_b32 s80, 1769472
    buffer_load_dwordx4 v2, s[28:31], s80 offen lds
    v_mfma_f32_32x32x16_bf16 v[160:175], a[212:215], a[180:183], v[160:175]
    v_mul_f32 v155, v155, v219
    v_mul_f32 v156, v156, v220
    v_mul_f32 v157, v157, v221
    v_mul_f32 v158, v158, v222
    s_add_u32 m0, s54, 106496
    s_waitcnt lgkmcnt(0)
    v_mfma_f32_32x32x16_bf16 v[160:175], a[216:219], a[184:187], v[160:175]
    v_mul_f32 v159, v159, v223
    v_cvt_pk_bf16_f32 v228, v152, v153
    v_cvt_pk_bf16_f32 v229, v154, v155
    s_mov_b32 s80, 98304
    v_mfma_f32_32x32x16_bf16 v[160:175], a[220:223], a[188:191], v[160:175]
    s_cmp_lg_u32 s48, 3
    s_cbranch_scc1 Lpolld35
    s_waitcnt lgkmcnt(0)
    s_cmp_lt_u32 s69, 7
    s_cbranch_scc1 Lpoll34
Lpolld35:
    v_cvt_pk_bf16_f32 v230, v156, v157
    v_cvt_pk_bf16_f32 v231, v158, v159
    buffer_store_dwordx4 v[228:231], v31, s[36:39], s82 offen offset:512 sc1
    buffer_load_dwordx4 v2, s[28:31], s80 offen lds
    s_waitcnt vmcnt(15)
    s_barrier
    ds_read_b64_tr_b16 a[192:193], v92 offset:4096
    s_cmp_lg_u32 s0, 0
    s_cbranch_scc1 Lsg36
    s_atomic_add s1, s[36:37], s67 offset:4
Lsg36:
    s_mov_b32 s98, 0
    ds_read_b64_tr_b16 a[194:195], v92 offset:4608
    ds_read_b64_tr_b16 a[196:197], v93 offset:4096
    ds_read_b64_tr_b16 a[198:199], v93 offset:4608
    ds_read_b64_tr_b16 a[200:201], v92 offset:8192
    buffer_load_dwordx4 a[32:35], v22, s[36:39], s98 offen offset:0 sc1
    ds_read_b64_tr_b16 a[202:203], v92 offset:8704
    ds_read_b64_tr_b16 a[204:205], v93 offset:8192
    ds_read_b64_tr_b16 a[206:207], v93 offset:8704
    ds_read_b64_tr_b16 a[208:209], v92 offset:12288
    ds_read_b64_tr_b16 a[210:211], v92 offset:12800
    ds_read_b64_tr_b16 a[212:213], v93 offset:12288
    ds_read_b64_tr_b16 a[214:215], v93 offset:12800
    s_mov_b32 s82, 12582912
    s_mov_b32 s98, 4096
    v_pk_fma_f32 v[160:161], v[192:193], v[176:177], v[160:161] op_sel:[0,0,0] op_sel_hi:[1,0,1] neg_lo:[0,1,0] neg_hi:[0,1,0]
    v_pk_fma_f32 v[162:163], v[194:195], v[176:177], v[162:163] op_sel:[0,0,0] op_sel_hi:[1,0,1] neg_lo:[0,1,0] neg_hi:[0,1,0]
    v_pk_fma_f32 v[164:165], v[196:197], v[176:177], v[164:165] op_sel:[0,0,0] op_sel_hi:[1,0,1] neg_lo:[0,1,0] neg_hi:[0,1,0]
    v_pk_fma_f32 v[166:167], v[198:199], v[176:177], v[166:167] op_sel:[0,0,0] op_sel_hi:[1,0,1] neg_lo:[0,1,0] neg_hi:[0,1,0]
    v_pk_fma_f32 v[168:169], v[200:201], v[176:177], v[168:169] op_sel:[0,0,0] op_sel_hi:[1,0,1] neg_lo:[0,1,0] neg_hi:[0,1,0]
    v_pk_fma_f32 v[170:171], v[202:203], v[176:177], v[170:171] op_sel:[0,0,0] op_sel_hi:[1,0,1] neg_lo:[0,1,0] neg_hi:[0,1,0]
    v_pk_fma_f32 v[172:173], v[204:205], v[176:177], v[172:173] op_sel:[0,0,0] op_sel_hi:[1,0,1] neg_lo:[0,1,0] neg_hi:[0,1,0]
    v_pk_fma_f32 v[174:175], v[206:207], v[176:177], v[174:175] op_sel:[0,0,0] op_sel_hi:[1,0,1] neg_lo:[0,1,0] neg_hi:[0,1,0]
    buffer_load_dwordx4 a[36:39], v22, s[36:39], s98 offen offset:0 sc1
    v_pk_mul_f32 v[160:161], v[160:161], v[176:177] op_sel:[0,1] op_sel_hi:[1,1]
    v_pk_mul_f32 v[162:163], v[162:163], v[176:177] op_sel:[0,1] op_sel_hi:[1,1]
    v_pk_mul_f32 v[164:165], v[164:165], v[176:177] op_sel:[0,1] op_sel_hi:[1,1]
    v_pk_mul_f32 v[166:167], v[166:167], v[176:177] op_sel:[0,1] op_sel_hi:[1,1]
    v_pk_mul_f32 v[168:169], v[168:169], v[176:177] op_sel:[0,1] op_sel_hi:[1,1]
    v_pk_mul_f32 v[170:171], v[170:171], v[176:177] op_sel:[0,1] op_sel_hi:[1,1]
    v_pk_mul_f32 v[172:173], v[172:173], v[176:177] op_sel:[0,1] op_sel_hi:[1,1]
    v_pk_mul_f32 v[174:175], v[174:175], v[176:177] op_sel:[0,1] op_sel_hi:[1,1]
    s_mov_b32 s98, 8192
    v_pk_mul_f32 v[208:209], v[160:161], v[160:161]
    v_pk_mul_f32 v[210:211], v[162:163], v[162:163]
    v_pk_mul_f32 v[212:213], v[164:165], v[164:165]
    v_pk_mul_f32 v[214:215], v[166:167], v[166:167]
    v_pk_mul_f32 v[216:217], v[168:169], v[168:169]
    v_pk_mul_f32 v[218:219], v[170:171], v[170:171]
    v_pk_mul_f32 v[220:221], v[172:173], v[172:173]
    buffer_load_dwordx4 a[40:43], v22, s[36:39], s98 offen offset:0 sc1
    v_pk_mul_f32 v[222:223], v[174:175], v[174:175]
    v_pk_fma_f32 v[208:209], v[208:209], s[100:101], v[40:41]
    v_pk_fma_f32 v[210:211], v[210:211], s[100:101], v[40:41]
    v_pk_fma_f32 v[212:213], v[212:213], s[100:101], v[40:41]
    v_pk_fma_f32 v[214:215], v[214:215], s[100:101], v[40:41]
    v_pk_fma_f32 v[216:217], v[216:217], s[100:101], v[40:41]
    v_pk_fma_f32 v[218:219], v[218:219], s[100:101], v[40:41]
    v_pk_fma_f32 v[220:221], v[220:221], s[100:101], v[40:41]
    s_mov_b32 s98, 12288
    v_pk_fma_f32 v[222:223], v[222:223], s[100:101], v[40:41]
    v_pk_mul_f32 v[208:209], v[208:209], v[160:161]
    v_pk_mul_f32 v[210:211], v[210:211], v[162:163]
    v_pk_mul_f32 v[212:213], v[212:213], v[164:165]
    v_pk_mul_f32 v[214:215], v[214:215], v[166:167]
    v_pk_mul_f32 v[216:217], v[216:217], v[168:169]
    v_pk_mul_f32 v[218:219], v[218:219], v[170:171]
    v_pk_mul_f32 v[220:221], v[220:221], v[172:173]
    buffer_load_dwordx4 a[44:47], v22, s[36:39], s98 offen offset:0 sc1
    v_pk_mul_f32 v[222:223], v[222:223], v[174:175]
    v_exp_f32 v208, v208
    v_exp_f32 v209, v209
    v_exp_f32 v210, v210
    v_exp_f32 v211, v211
    s_mov_b32 s98, 16384
    v_exp_f32 v212, v212
    v_exp_f32 v213, v213
    v_exp_f32_e64 v214, v214
    buffer_load_dwordx4 a[48:51], v22, s[36:39], s98 offen offset:0 sc1
    v_exp_f32 v215, v215
    v_exp_f32 v216, v216
    v_exp_f32 v217, v217
    v_exp_f32 v218, v218
    s_mov_b32 s98, 20480
    v_exp_f32 v219, v219
    v_exp_f32 v220, v220
    v_exp_f32 v221, v221
    v_exp_f32 v222, v222
    buffer_load_dwordx4 a[52:55], v22, s[36:39], s98 offen offset:0 sc1
    v_exp_f32_e64 v223, v223
    v_pk_add_f32 v[208:209], v[208:209], 1.0 op_sel_hi:[1,0]
    v_pk_add_f32 v[210:211], v[210:211], 1.0 op_sel_hi:[1,0]
    v_pk_add_f32 v[212:213], v[212:213], 1.0 op_sel_hi:[1,0]
    v_pk_add_f32 v[214:215], v[214:215], 1.0 op_sel_hi:[1,0]
    v_pk_add_f32 v[216:217], v[216:217], 1.0 op_sel_hi:[1,0]
    v_pk_add_f32 v[218:219], v[218:219], 1.0 op_sel_hi:[1,0]
    s_mov_b32 s98, 24576
    v_pk_add_f32 v[220:221], v[220:221], 1.0 op_sel_hi:[1,0]
    v_pk_add_f32 v[222:223], v[222:223], 1.0 op_sel_hi:[1,0]
    v_rcp_f32 v208, v208
    v_rcp_f32 v209, v209
    v_rcp_f32_e64 v210, v210
    buffer_load_dwordx4 a[56:59], v22, s[36:39], s98 offen offset:0 sc1
    v_rcp_f32 v211, v211
    v_rcp_f32 v212, v212
    v_rcp_f32 v213, v213
    v_rcp_f32 v214, v214
    v_rcp_f32 v215, v215
    v_rcp_f32 v216, v216
    v_rcp_f32 v217, v217
    v_rcp_f32 v218, v218
    v_rcp_f32 v219, v219
    v_rcp_f32 v220, v220
    v_rcp_f32 v221, v221
    v_rcp_f32 v222, v222
    v_rcp_f32_e64 v223, v223
    v_pk_mul_f32 v[160:161], v[160:161], v[208:209]
    v_pk_mul_f32 v[162:163], v[162:163], v[210:211]
    v_pk_mul_f32 v[164:165], v[164:165], v[212:213]
    v_pk_mul_f32 v[166:167], v[166:167], v[214:215]
    v_pk_mul_f32 v[168:169], v[168:169], v[216:217]
    v_pk_mul_f32 v[170:171], v[170:171], v[218:219]
    v_pk_mul_f32 v[172:173], v[172:173], v[220:221]
    v_pk_mul_f32 v[174:175], v[174:175], v[222:223]
    v_cvt_pk_bf16_f32 v232, v160, v161
    v_cvt_pk_bf16_f32 v233, v162, v163
    v_cvt_pk_bf16_f32 v234, v164, v165
    v_cvt_pk_bf16_f32 v235, v166, v167
    v_cvt_pk_bf16_f32 v236, v168, v169
    v_cvt_pk_bf16_f32 v237, v170, v171
    v_cvt_pk_bf16_f32 v238, v172, v173
    v_cvt_pk_bf16_f32 v239, v174, v175
Ljoin1:
    s_waitcnt vmcnt(8)
    s_barrier
    s_waitcnt lgkmcnt(8)
    s_nop 0
    v_mfma_f32_32x32x16_bf16 v[144:159], a[196:199], a[0:3], 0
    ds_read_b64_tr_b16 a[216:217], v92 offset:16384
    ds_read_b64_tr_b16 a[218:219], v92 offset:16896
    buffer_store_dwordx4 v[232:235], v31, s[36:39], s82 offen offset:0 sc1
    buffer_store_dwordx4 v[236:239], v31, s[36:39], s82 offen offset:512 sc1
    s_cmp_lg_u32 s0, 0
    s_cbranch_scc1 Lsg43
    s_atomic_add s1, s[36:37], s67 offset:256
Lsg43:
    s_cmp_lg_u32 s48, 3
    s_cbranch_scc1 Lpi44
    s_load_dword s69, s[36:37], s64 offset:4 glc
Lpi44:
    s_mov_b32 s98, 0
    s_nop 0
    v_mfma_f32_32x32x16_bf16 v[128:143], a[192:195], a[0:3], 0
    ds_read_b64_tr_b16 a[220:221], v93 offset:16384
    ds_read_b64_tr_b16 a[222:223], v93 offset:16896
    buffer_load_dwordx4 a[60:63], v23, s[36:39], s98 offen offset:0 sc1
    s_mov_b32 s98, 4096
    v_mfma_f32_32x32x16_bf16 v[70:85], a[196:199], a[4:7], 0
    buffer_load_dwordx4 a[224:227], v23, s[36:39], s98 offen offset:0 sc1
    v_mfma_f32_32x32x16_bf16 v[54:69], a[192:195], a[4:7], v[54:69]
    ds_write_b128 v110, v[112:115] offset:45056
    s_mov_b32 s98, 8192
    buffer_load_dwordx4 a[228:231], v23, s[36:39], s98 offen offset:0 sc1
    s_waitcnt lgkmcnt(9)
    s_nop 0
    v_mfma_f32_32x32x16_bf16 v[144:159], a[204:207], a[8:11], v[144:159]
    ds_read_b64_tr_b16 a[192:193], v94 offset:28672
    ds_read_b64_tr_b16 a[194:195], v94 offset:29184
    s_mov_b32 s98, 12288
    v_mfma_f32_32x32x16_bf16 v[128:143], a[200:203], a[8:11], v[128:143]
    ds_read_b64_tr_b16 a[196:197], v95 offset:28672
    ds_read_b64_tr_b16 a[198:199], v95 offset:29184
    buffer_load_dwordx4 a[232:235], v23, s[36:39], s98 offen offset:0 sc1
    v_mfma_f32_32x32x16_bf16 v[70:85], a[204:207], a[12:15], v[70:85]
    ds_write_b128 v110, v[116:119] offset:40960
    s_mov_b32 s98, 16384
    buffer_load_dwordx4 a[236:239], v23, s[36:39], s98 offen offset:0 sc1
    v_mfma_f32_32x32x16_bf16 v[54:69], a[200:203], a[12:15], v[54:69]
    s_mov_b32 s98, 20480
    s_waitcnt lgkmcnt(10)
    s_nop 0
    v_mfma_f32_32x32x16_bf16 v[144:159], a[212:215], a[16:19], v[144:159]
    ds_read_b64_tr_b16 a[200:201], v90 offset:0
    ds_read_b64_tr_b16 a[202:203], v90 offset:512
    buffer_load_dwordx4 a[240:243], v23, s[36:39], s98 offen offset:0 sc1
    v_mfma_f32_32x32x16_bf16 v[128:143], a[208:211], a[16:19], v[128:143]
    ds_read_b64_tr_b16 a[204:205], v91 offset:0
    ds_read_b64_tr_b16 a[206:207], v91 offset:512
    ds_write_b128 v110, v[120:123] offset:36864
    s_mov_b32 s98, 24576
    buffer_load_dwordx4 a[244:247], v23, s[36:39], s98 offen offset:0 sc1
    v_mfma_f32_32x32x16_bf16 v[70:85], a[212:215], a[20:23], v[70:85]
    s_add_u32 m0, s54, 110592
    v_mfma_f32_32x32x16_bf16 v[54:69], a[208:211], a[20:23], v[54:69]
    s_mov_b32 s80, 229376
    buffer_load_dwordx4 v2, s[28:31], s80 offen lds
    s_waitcnt lgkmcnt(11)
    s_nop 0
    v_mfma_f32_32x32x16_bf16 v[144:159], a[220:223], a[24:27], v[144:159]
    ds_read_b64_tr_b16 a[208:209], v90 offset:4096
    ds_read_b64_tr_b16 a[210:211], v90 offset:4608
    v_mfma_f32_32x32x16_bf16 v[128:143], a[216:219], a[24:27], v[128:143]
    ds_read_b64_tr_b16 a[212:213], v91 offset:4096
    ds_read_b64_tr_b16 a[214:215], v91 offset:4608
    ds_write_b128 v110, v[124:127] offset:32768
    v_mfma_f32_32x32x16_bf16 v[70:85], a[220:223], a[28:31], v[70:85]
    v_mfma_f32_32x32x16_bf16 v[54:69], a[216:219], a[28:31], v[54:69]
    s_cmp_lg_u32 s48, 3
    s_cbranch_scc1 Lpolld46
    s_waitcnt lgkmcnt(0)
    s_cmp_lt_u32 s69, 7
    s_cbranch_scc1 Lpoll45
Lpolld46:
    s_waitcnt lgkmcnt(0)
    s_barrier
    s_waitcnt vmcnt(16)
    v_mfma_f32_32x32x16_bf16 v[144:159], a[196:199], a[32:35], v[144:159]
    ds_read_b64_tr_b16 a[216:217], v90 offset:8192
    ds_read_b64_tr_b16 a[218:219], v90 offset:8704
    s_mov_b32 s98, 0
    s_nop 0
    buffer_load_dwordx4 a[248:251], v22, s[36:39], s98 offen offset:2048 sc1
    v_mfma_f32_32x32x16_bf16 v[128:143], a[192:195], a[32:35], v[128:143]
    ds_read_b64_tr_b16 a[220:221], v91 offset:8192
    ds_read_b64_tr_b16 a[222:223], v91 offset:8704
    s_mov_b32 s98, 4096
    buffer_load_dwordx4 a[252:255], v22, s[36:39], s98 offen offset:2048 sc1
    s_waitcnt vmcnt(17)
    s_nop 0
    v_mfma_f32_32x32x16_bf16 v[144:159], a[204:207], a[36:39], v[144:159]
    ds_read_b64_tr_b16 a[192:193], v90 offset:12288
    ds_read_b64_tr_b16 a[194:195], v90 offset:12800
    s_mov_b32 s98, 8192
    buffer_load_dwordx4 a[64:67], v22, s[36:39], s98 offen offset:2048 sc1
    v_mfma_f32_32x32x16_bf16 v[128:143], a[200:203], a[36:39], v[128:143]
    ds_read_b64_tr_b16 a[196:197], v91 offset:12288
    ds_read_b64_tr_b16 a[198:199], v91 offset:12800
    s_mov_b32 s98, 12288
    buffer_load_dwordx4 a[68:71], v22, s[36:39], s98 offen offset:2048 sc1
    s_waitcnt vmcnt(18)
    s_nop 0
    v_mfma_f32_32x32x16_bf16 v[144:159], a[212:215], a[40:43], v[144:159]
    ds_read_b64_tr_b16 a[200:201], v90 offset:16384
    ds_read_b64_tr_b16 a[202:203], v90 offset:16896
    s_mov_b32 s98, 16384
    buffer_load_dwordx4 a[72:75], v22, s[36:39], s98 offen offset:2048 sc1
    v_mfma_f32_32x32x16_bf16 v[128:143], a[208:211], a[40:43], v[128:143]
    ds_read_b64_tr_b16 a[204:205], v91 offset:16384
    ds_read_b64_tr_b16 a[206:207], v91 offset:16896
    s_mov_b32 s98, 20480
    buffer_load_dwordx4 a[76:79], v22, s[36:39], s98 offen offset:2048 sc1
    s_waitcnt vmcnt(19) lgkmcnt(8)
    s_nop 0
    v_mfma_f32_32x32x16_bf16 v[144:159], a[220:223], a[44:47], v[144:159]
    ds_read_b64_tr_b16 a[208:209], v90 offset:20480
    ds_read_b64_tr_b16 a[210:211], v90 offset:20992
    s_mov_b32 s98, 24576
    buffer_load_dwordx4 a[80:83], v22, s[36:39], s98 offen offset:2048 sc1
    v_mfma_f32_32x32x16_bf16 v[128:143], a[216:219], a[44:47], v[128:143]
    ds_read_b64_tr_b16 a[212:213], v91 offset:20480
    ds_read_b64_tr_b16 a[214:215], v91 offset:20992
    s_waitcnt vmcnt(15)
    s_barrier
    s_waitcnt lgkmcnt(8)
    s_nop 0
    v_mfma_f32_32x32x16_bf16 v[144:159], a[196:199], a[48:51], v[144:159]
    ds_read_b64_tr_b16 a[216:217], v90 offset:24576
    ds_read_b64_tr_b16 a[218:219], v90 offset:25088
    s_cmp_lg_u32 s48, 0
    s_cbranch_scc1 Lsg47
    s_atomic_add s1, s[36:37], s67 offset:384
Lsg47:
    s_cmp_lg_u32 s48, 3
    s_cbranch_scc1 Lpi48
    s_load_dword s69, s[36:37], s64 offset:256 glc
    s_load_dword s70, s[36:37], s65 offset:256 glc
Lpi48:
    s_mov_b32 s98, 0
    s_nop 0
    v_mfma_f32_32x32x16_bf16 v[128:143], a[192:195], a[48:51], v[128:143]
    ds_read_b64_tr_b16 a[220:221], v91 offset:24576
    ds_read_b64_tr_b16 a[222:223], v91 offset:25088
    buffer_load_dwordx4 a[84:87], v23, s[36:39], s98 offen offset:2048 sc1
    s_mov_b32 s98, 4096
    s_waitcnt lgkmcnt(8)
    s_nop 0
    v_mfma_f32_32x32x16_bf16 v[144:159], a[204:207], a[52:55], v[144:159]
    ds_read_b64_tr_b16 a[192:193], v90 offset:28672
    ds_read_b64_tr_b16 a[194:195], v90 offset:29184
    buffer_load_dwordx4 a[88:91], v23, s[36:39], s98 offen offset:2048 sc1
    v_mfma_f32_32x32x16_bf16 v[128:143], a[200:203], a[52:55], v[128:143]
    ds_read_b64_tr_b16 a[196:197], v91 offset:28672
    ds_read_b64_tr_b16 a[198:199], v91 offset:29184
    s_mov_b32 s98, 8192
    buffer_load_dwordx4 a[92:95], v23, s[36:39], s98 offen offset:2048 sc1
    s_waitcnt lgkmcnt(8)
    s_nop 0
    v_mfma_f32_32x32x16_bf16 v[144:159], a[212:215], a[56:59], v[144:159]
    ds_read_b64_tr_b16 a[200:201], v90 offset:32768
    ds_read_b64_tr_b16 a[202:203], v90 offset:33280
    s_mov_b32 s98, 12288
    v_mfma_f32_32x32x16_bf16 v[128:143], a[208:211], a[56:59], v[128:143]
    ds_read_b64_tr_b16 a[204:205], v91 offset:32768
    ds_read_b64_tr_b16 a[206:207], v91 offset:33280
    buffer_load_dwordx4 a[96:99], v23, s[36:39], s98 offen offset:2048 sc1
    s_waitcnt vmcnt(10) lgkmcnt(8)
    s_nop 0
    v_mfma_f32_32x32x16_bf16 v[144:159], a[220:223], a[248:251], v[144:159]
    ds_read_b64_tr_b16 a[208:209], v90 offset:36864
    ds_read_b64_tr_b16 a[210:211], v90 offset:37376
    s_add_u32 m0, s54, 65536
    s_mov_b32 s80, 360448
    v_mfma_f32_32x32x16_bf16 v[128:143], a[216:219], a[248:251], v[128:143]
    ds_read_b64_tr_b16 a[212:213], v91 offset:36864
    ds_read_b64_tr_b16 a[214:215], v91 offset:37376
    buffer_load_dwordx4 v2, s[28:31], s80 offen lds
    s_mov_b32 s98, 16384
    s_waitcnt vmcnt(10) lgkmcnt(8)
    s_nop 0
    v_mfma_f32_32x32x16_bf16 v[144:159], a[196:199], a[252:255], v[144:159]
    ds_read_b64_tr_b16 a[216:217], v94 offset:24576
    ds_read_b64_tr_b16 a[218:219], v94 offset:25088
    buffer_load_dwordx4 a[100:103], v23, s[36:39], s98 offen offset:2048 sc1
    v_mfma_f32_32x32x16_bf16 v[128:143], a[192:195], a[252:255], v[128:143]
    ds_read_b64_tr_b16 a[220:221], v95 offset:24576
    ds_read_b64_tr_b16 a[222:223], v95 offset:25088
    s_add_u32 m0, s54, 69632
    s_mov_b32 s80, 491520
    s_waitcnt vmcnt(10) lgkmcnt(8)
    s_nop 0
    v_mfma_f32_32x32x16_bf16 v[144:159], a[204:207], a[64:67], v[144:159]
    ds_read_b64_tr_b16 a[192:193], v90 offset:40960
    ds_read_b64_tr_b16 a[194:195], v90 offset:41472
    buffer_load_dwordx4 v2, s[28:31], s80 offen lds
    s_mov_b32 s98, 20480
    v_mfma_f32_32x32x16_bf16 v[128:143], a[200:203], a[64:67], v[128:143]
    ds_read_b64_tr_b16 a[196:197], v91 offset:40960
    ds_read_b64_tr_b16 a[198:199], v91 offset:41472
    buffer_load_dwordx4 a[104:107], v23, s[36:39], s98 offen offset:2048 sc1
    s_waitcnt vmcnt(11) lgkmcnt(8)
    s_nop 0
    v_mfma_f32_32x32x16_bf16 v[144:159], a[212:215], a[68:71], v[144:159]
    ds_read_b64_tr_b16 a[200:201], v90 offset:45056
    ds_read_b64_tr_b16 a[202:203], v90 offset:45568
    s_add_u32 m0, s54, 73728
    s_mov_b32 s80, 622592
    v_mfma_f32_32x32x16_bf16 v[128:143], a[208:211], a[68:71], v[128:143]
    ds_read_b64_tr_b16 a[204:205], v91 offset:45056
    ds_read_b64_tr_b16 a[206:207], v91 offset:45568
    buffer_load_dwordx4 v2, s[28:31], s80 offen lds
    s_mov_b32 s98, 24576
    s_waitcnt vmcnt(11) lgkmcnt(8)
    s_nop 0
    v_mfma_f32_32x32x16_bf16 v[144:159], a[220:223], a[72:75], v[144:159]
    ds_read_b64_tr_b16 a[208:209], v94 offset:28672
    ds_read_b64_tr_b16 a[210:211], v94 offset:29184
    buffer_load_dwordx4 a[108:111], v23, s[36:39], s98 offen offset:2048 sc1
    s_waitcnt vmcnt(11) lgkmcnt(6)
    s_nop 0
    v_mfma_f32_32x32x16_bf16 v[144:159], a[196:199], a[76:79], v[144:159]
    ds_read_b64_tr_b16 a[212:213], v95 offset:28672
    ds_read_b64_tr_b16 a[214:215], v95 offset:29184
    s_add_u32 m0, s54, 77824
    s_mov_b32 s80, 753664
    s_waitcnt vmcnt(10) lgkmcnt(4)
    s_nop 0
    v_mfma_f32_32x32x16_bf16 v[144:159], a[204:207], a[80:83], v[144:159]
    buffer_load_dwordx4 v2, s[28:31], s80 offen lds
    v_mfma_f32_32x32x16_bf16 v[128:143], a[216:219], a[72:75], v[128:143]
    v_mfma_f32_32x32x16_bf16 v[128:143], a[192:195], a[76:79], v[128:143]
    ds_read_b64_tr_b16 a[216:217], v90 offset:0
    ds_read_b64_tr_b16 a[218:219], v90 offset:512
    ds_read_b64_tr_b16 a[220:221], v91 offset:0
    ds_read_b64_tr_b16 a[222:223], v91 offset:512
    s_nop 4
    s_nop 0
    ds_write_b128 v104, v[144:147] offset:0
    ds_write_b128 v104, v[148:151] offset:1024
    v_mfma_f32_32x32x16_bf16 v[128:143], a[200:203], a[80:83], v[128:143]
    ds_read_b64_tr_b16 a[192:193], v90 offset:4096
    ds_read_b64_tr_b16 a[194:195], v90 offset:4608
    ds_read_b64_tr_b16 a[196:197], v91 offset:4096
    ds_read_b64_tr_b16 a[198:199], v91 offset:4608
    ds_write_b128 v104, v[152:155] offset:2048
    ds_write_b128 v104, v[156:159] offset:3072
    s_cmp_lg_u32 s48, 3
    s_cbranch_scc1 Lpolld50
    s_waitcnt lgkmcnt(0)
    s_min_u32 s69, s69, s70
    s_cmp_lt_u32 s69, 7
    s_cbranch_scc1 Lpoll49
Lpolld50:
    s_waitcnt lgkmcnt(0)
    s_barrier
    v_mfma_f32_32x32x16_bf16 v[70:85], a[212:215], a[60:63], v[70:85]
    ds_read_b64_tr_b16 a[200:201], v90 offset:8192
    ds_read_b64_tr_b16 a[202:203], v90 offset:8704
    ds_read_b128 v[160:163], v105 offset:0
    ds_read_b128 v[164:167], v105 offset:1024
    ds_read_b128 v[168:171], v105 offset:2048
    ds_read_b128 v[172:175], v105 offset:3072
    s_mov_b32 s98, 10485760
    buffer_load_dwordx4 a[112:115], v14, s[36:39], s98 offen offset:0 sc1
    v_mfma_f32_32x32x16_bf16 v[54:69], a[208:211], a[60:63], v[54:69]
    ds_read_b64_tr_b16 a[204:205], v91 offset:8192
    ds_read_b64_tr_b16 a[206:207], v91 offset:8704
    s_waitcnt lgkmcnt(5)
    s_nop 0
    buffer_load_dwordx4 a[116:119], v14, s[36:39], s98 offen offset:2048 sc1
    v_mfma_f32_32x32x16_bf16 v[70:85], a[220:223], a[224:227], v[70:85]
    ds_read_b64_tr_b16 a[208:209], v90 offset:12288
    ds_read_b64_tr_b16 a[210:211], v90 offset:12800
    v_add_f32 v128, v128, v160
    v_add_f32 v129, v129, v161
    v_add_f32 v130, v130, v162
    v_add_f32 v131, v131, v163
    s_mov_b32 s98, 10489856
    v_mfma_f32_32x32x16_bf16 v[54:69], a[216:219], a[224:227], v[54:69]
    ds_read_b64_tr_b16 a[212:213], v91 offset:12288
    ds_read_b64_tr_b16 a[214:215], v91 offset:12800
    v_cvt_pk_bf16_f32 v176, v128, v129
    v_cvt_pk_bf16_f32 v177, v130, v131
    s_waitcnt lgkmcnt(8)
    v_add_f32 v132, v132, v164
    buffer_load_dwordx4 a[120:123], v14, s[36:39], s98 offen offset:0 sc1
    v_mfma_f32_32x32x16_bf16 v[70:85], a[196:199], a[228:231], v[70:85]
    ds_read_b64_tr_b16 a[216:217], v90 offset:16384
    ds_read_b64_tr_b16 a[218:219], v90 offset:16896
    v_add_f32 v133, v133, v165
    v_add_f32 v134, v134, v166
    v_add_f32_e64 v135, v135, v167
    v_cvt_pk_bf16_f32 v178, v132, v133
    v_cvt_pk_bf16_f32 v179, v134, v135
    buffer_load_dwordx4 a[124:127], v14, s[36:39], s98 offen offset:2048 sc1
    v_mfma_f32_32x32x16_bf16 v[54:69], a[192:195], a[228:231], v[54:69]
    ds_read_b64_tr_b16 a[220:221], v91 offset:16384
    ds_read_b64_tr_b16 a[222:223], v91 offset:16896
    buffer_store_dwordx4 v[176:179], v25, s[32:35], 0 offen offset:0 sc1
    s_waitcnt lgkmcnt(11)
    v_add_f32 v136, v136, v168
    v_add_f32_e64 v137, v137, v169
    s_mov_b32 s98, 10493952
    buffer_load_dwordx4 a[128:131], v14, s[36:39], s98 offen offset:0 sc1
    s_waitcnt lgkmcnt(8)
    s_nop 0
    v_mfma_f32_32x32x16_bf16 v[70:85], a[204:207], a[232:235], v[70:85]
    ds_read_b64_tr_b16 a[192:193], v90 offset:20480
    ds_read_b64_tr_b16 a[194:195], v90 offset:20992
    v_add_f32 v138, v138, v170
    v_add_f32 v139, v139, v171
    v_cvt_pk_bf16_f32 v180, v136, v137
    v_cvt_pk_bf16_f32 v181, v138, v139
    v_mfma_f32_32x32x16_bf16 v[54:69], a[200:203], a[232:235], v[54:69]
    ds_read_b64_tr_b16 a[196:197], v91 offset:20480
    ds_read_b64_tr_b16 a[198:199], v91 offset:20992
    v_add_f32 v140, v140, v172
    v_add_f32 v141, v141, v173
    v_add_f32_e64 v142, v142, v174
    buffer_load_dwordx4 a[132:135], v14, s[36:39], s98 offen offset:2048 sc1
    s_mov_b32 s98, 10498048
    s_waitcnt lgkmcnt(8)
    s_nop 0
    v_mfma_f32_32x32x16_bf16 v[70:85], a[212:215], a[236:239], v[70:85]
    ds_read_b64_tr_b16 a[200:201], v90 offset:24576
    ds_read_b64_tr_b16 a[202:203], v90 offset:25088
    v_add_f32_e64 v143, v143, v175
    v_cvt_pk_bf16_f32 v182, v140, v141
    v_cvt_pk_bf16_f32 v183, v142, v143
    buffer_store_dwordx4 v[180:183], v25, s[32:35], 0 offen offset:1024 sc1
    buffer_load_dwordx4 a[136:139], v14, s[36:39], s98 offen offset:0 sc1
    v_mfma_f32_32x32x16_bf16 v[54:69], a[208:211], a[236:239], v[54:69]
    ds_read_b64_tr_b16 a[204:205], v91 offset:24576
    ds_read_b64_tr_b16 a[206:207], v91 offset:25088
    s_barrier
    s_waitcnt lgkmcnt(8)
    v_mfma_f32_32x32x16_bf16 v[70:85], a[220:223], a[240:243], v[70:85]
    ds_read_b64_tr_b16 a[208:209], v90 offset:28672
    ds_read_b64_tr_b16 a[210:211], v90 offset:29184
    s_cmp_lg_u32 s48, 3
    s_cbranch_scc1 Lpi51
    s_load_dword s69, s[36:37], s64 offset:384 glc
    s_load_dword s70, s[36:37], s65 offset:384 glc
Lpi51:
    s_add_u32 m0, s54, 151552
    s_mov_b32 s80, 884736
    v_mfma_f32_32x32x16_bf16 v[54:69], a[216:219], a[240:243], v[54:69]
    ds_read_b64_tr_b16 a[212:213], v91 offset:28672
    ds_read_b64_tr_b16 a[214:215], v91 offset:29184
    buffer_load_dwordx4 v2, s[28:31], s80 offen lds
    s_add_u32 m0, s54, 0
    s_mov_b32 s80, 1015808
    s_waitcnt lgkmcnt(8)
    v_mfma_f32_32x32x16_bf16 v[70:85], a[196:199], a[244:247], v[70:85]
    ds_read_b64_tr_b16 a[216:217], v90 offset:32768
    ds_read_b64_tr_b16 a[218:219], v90 offset:33280
    buffer_load_dwordx4 v2, s[28:31], s80 offen lds
    s_add_u32 m0, s54, 4096
    v_mfma_f32_32x32x16_bf16 v[54:69], a[192:195], a[244:247], v[54:69]
    ds_read_b64_tr_b16 a[220:221], v91 offset:32768
    ds_read_b64_tr_b16 a[222:223], v91 offset:33280
    s_mov_b32 s80, 1146880
    buffer_load_dwordx4 v2, s[28:31], s80 offen lds
    s_waitcnt vmcnt(22) lgkmcnt(8)
    s_nop 0
    v_mfma_f32_32x32x16_bf16 v[70:85], a[204:207], a[84:87], v[70:85]
    ds_read_b64_tr_b16 a[192:193], v90 offset:36864
    ds_read_b64_tr_b16 a[194:195], v90 offset:37376
    s_add_u32 m0, s54, 8192
    s_mov_b32 s80, 1277952
    v_mfma_f32_32x32x16_bf16 v[54:69], a[200:203], a[84:87], v[54:69]
    ds_read_b64_tr_b16 a[196:197], v91 offset:36864
    ds_read_b64_tr_b16 a[198:199], v91 offset:37376
    buffer_load_dwordx4 v2, s[28:31], s80 offen lds
    s_add_u32 m0, s54, 12288
    s_waitcnt vmcnt(22) lgkmcnt(8)
    s_nop 0
    v_mfma_f32_32x32x16_bf16 v[70:85], a[212:215], a[88:91], v[70:85]
    ds_read_b64_tr_b16 a[200:201], v94 offset:24576
    ds_read_b64_tr_b16 a[202:203], v94 offset:25088
    s_mov_b32 s80, 1409024
    buffer_load_dwordx4 v2, s[28:31], s80 offen lds
    s_mov_b32 s98, 10502144
    v_mfma_f32_32x32x16_bf16 v[54:69], a[208:211], a[88:91], v[54:69]
    ds_read_b64_tr_b16 a[204:205], v95 offset:24576
    ds_read_b64_tr_b16 a[206:207], v95 offset:25088
    buffer_load_dwordx4 a[140:143], v14, s[36:39], s98 offen offset:0 sc1
    s_waitcnt vmcnt(23) lgkmcnt(8)
    s_nop 0
    v_mfma_f32_32x32x16_bf16 v[70:85], a[220:223], a[92:95], v[70:85]
    ds_read_b64_tr_b16 a[208:209], v90 offset:40960
    ds_read_b64_tr_b16 a[210:211], v90 offset:41472
    v_mfma_f32_32x32x16_bf16 v[54:69], a[216:219], a[92:95], v[54:69]
    ds_read_b64_tr_b16 a[212:213], v91 offset:40960
    ds_read_b64_tr_b16 a[214:215], v91 offset:41472
    buffer_load_dwordx4 a[144:147], v14, s[36:39], s98 offen offset:2048 sc1
    s_mov_b32 s98, 10506240
    s_waitcnt vmcnt(23) lgkmcnt(8)
    s_nop 0
    v_mfma_f32_32x32x16_bf16 v[70:85], a[196:199], a[96:99], v[70:85]
    ds_read_b64_tr_b16 a[216:217], v90 offset:45056
    ds_read_b64_tr_b16 a[218:219], v90 offset:45568
    buffer_load_dwordx4 a[148:151], v14, s[36:39], s98 offen offset:0 sc1
    v_mfma_f32_32x32x16_bf16 v[54:69], a[192:195], a[96:99], v[54:69]
    ds_read_b64_tr_b16 a[220:221], v91 offset:45056
    ds_read_b64_tr_b16 a[222:223], v91 offset:45568
    buffer_load_dwordx4 a[152:155], v14, s[36:39], s98 offen offset:2048 sc1
    s_waitcnt vmcnt(23) lgkmcnt(8)
    s_nop 0
    v_mfma_f32_32x32x16_bf16 v[70:85], a[204:207], a[100:103], v[70:85]
    ds_read_b64_tr_b16 a[192:193], v90 offset:49152
    ds_read_b64_tr_b16 a[194:195], v90 offset:49664
    s_mov_b32 s98, 10510336
    v_mfma_f32_32x32x16_bf16 v[54:69], a[200:203], a[100:103], v[54:69]
    ds_read_b64_tr_b16 a[196:197], v91 offset:49152
    ds_read_b64_tr_b16 a[198:199], v91 offset:49664
    buffer_load_dwordx4 a[156:159], v14, s[36:39], s98 offen offset:0 sc1
    s_waitcnt vmcnt(22) lgkmcnt(8)
    s_nop 0
    v_mfma_f32_32x32x16_bf16 v[70:85], a[212:215], a[104:107], v[70:85]
    ds_read_b64_tr_b16 a[200:201], v90 offset:53248
    ds_read_b64_tr_b16 a[202:203], v90 offset:53760
    buffer_load_dwordx4 a[160:163], v14, s[36:39], s98 offen offset:2048 sc1
    v_mfma_f32_32x32x16_bf16 v[54:69], a[208:211], a[104:107], v[54:69]
    ds_read_b64_tr_b16 a[204:205], v91 offset:53248
    ds_read_b64_tr_b16 a[206:207], v91 offset:53760
    s_waitcnt vmcnt(12)
    s_barrier
    s_waitcnt lgkmcnt(8)
    s_nop 0
    v_mfma_f32_32x32x16_bf16 v[70:85], a[220:223], a[108:111], v[70:85]
    ds_read_b64_tr_b16 a[208:209], v90 offset:57344
    ds_read_b64_tr_b16 a[210:211], v90 offset:57856
    s_cmp_lg_u32 s48, 0
    s_cbranch_scc1 Lsg52
    s_atomic_add s1, s[36:37], s58 offset:144
Lsg52:
    s_add_u32 m0, s54, 16384
    s_mov_b32 s80, 1540096
    v_mfma_f32_32x32x16_bf16 v[54:69], a[216:219], a[108:111], v[54:69]
    ds_read_b64_tr_b16 a[212:213], v91 offset:57344
    ds_read_b64_tr_b16 a[214:215], v91 offset:57856
    buffer_load_dwordx4 v2, s[28:31], s80 offen lds
    s_add_u32 m0, s54, 20480
    s_waitcnt lgkmcnt(8)
    s_nop 0
    v_mfma_f32_32x32x16_bf16 v[70:85], a[196:199], a[112:115], v[70:85]
    ds_read_b64_tr_b16 a[216:217], v92 offset:0
    ds_read_b64_tr_b16 a[218:219], v92 offset:512
    s_mov_b32 s80, 1671168
    buffer_load_dwordx4 v2, s[28:31], s80 offen lds
    v_mfma_f32_32x32x16_bf16 v[54:69], a[192:195], a[112:115], v[54:69]
    ds_read_b64_tr_b16 a[220:221], v93 offset:0
    ds_read_b64_tr_b16 a[222:223], v93 offset:512
    s_add_u32 m0, s54, 24576
    s_mov_b32 s80, 1802240
    s_waitcnt lgkmcnt(8)
    s_nop 0
    v_mfma_f32_32x32x16_bf16 v[70:85], a[204:207], a[116:119], v[70:85]
    ds_read_b64_tr_b16 a[192:193], v94 offset:4096
    ds_read_b64_tr_b16 a[194:195], v94 offset:4608
    buffer_load_dwordx4 v2, s[28:31], s80 offen lds
    s_mov_b32 s98, 10514432
    v_mfma_f32_32x32x16_bf16 v[54:69], a[200:203], a[116:119], v[54:69]
    ds_read_b64_tr_b16 a[196:197], v95 offset:4096
    ds_read_b64_tr_b16 a[198:199], v95 offset:4608
    buffer_load_dwordx4 a[164:167], v14, s[36:39], s98 offen offset:0 sc1
    s_waitcnt lgkmcnt(8)
    s_nop 0
    v_mfma_f32_32x32x16_bf16 v[70:85], a[212:215], a[120:123], v[70:85]
    ds_read_b64_tr_b16 a[200:201], v94 offset:0
    ds_read_b64_tr_b16 a[202:203], v94 offset:512
    v_mfma_f32_32x32x16_bf16 v[54:69], a[208:211], a[120:123], v[54:69]
    ds_read_b64_tr_b16 a[204:205], v95 offset:0
    ds_read_b64_tr_b16 a[206:207], v95 offset:512
    s_cmp_lg_u32 s48, 3
    s_cbranch_scc1 Lpolld54
    s_waitcnt lgkmcnt(0)
    s_min_u32 s69, s69, s70
    s_cmp_lt_u32 s69, 8
    s_cbranch_scc1 Lpoll53
Lpolld54:
    s_barrier
    s_waitcnt lgkmcnt(8)
    v_mfma_f32_32x32x16_bf16 v[70:85], a[220:223], a[124:127], v[70:85]
    ds_read_b64_tr_b16 a[208:209], v92 offset:57344
    ds_read_b64_tr_b16 a[210:211], v92 offset:57856
    s_mov_b32 s98, 12582912
    buffer_load_dwordx4 a[168:171], v14, s[36:39], s98 offen offset:0 sc1
    v_mfma_f32_32x32x16_bf16 v[54:69], a[216:219], a[124:127], v[54:69]
    ds_read_b64_tr_b16 a[212:213], v93 offset:57344
    ds_read_b64_tr_b16 a[214:215], v93 offset:57856
    buffer_load_dwordx4 a[172:175], v14, s[36:39], s98 offen offset:2048 sc1
    s_waitcnt lgkmcnt(8)
    s_nop 0
    v_mfma_f32_32x32x16_bf16 v[70:85], a[196:199], a[128:131], v[70:85]
    ds_read_b64_tr_b16 a[216:217], v92 offset:53248
    ds_read_b64_tr_b16 a[218:219], v92 offset:53760
    s_mov_b32 s98, 12587008
    buffer_load_dwordx4 a[176:179], v14, s[36:39], s98 offen offset:0 sc1
    v_mfma_f32_32x32x16_bf16 v[54:69], a[192:195], a[128:131], v[54:69]
    ds_read_b64_tr_b16 a[220:221], v93 offset:53248
    ds_read_b64_tr_b16 a[222:223], v93 offset:53760
    buffer_load_dwordx4 a[180:183], v14, s[36:39], s98 offen offset:2048 sc1
    s_waitcnt lgkmcnt(8)
    s_nop 0
    v_mfma_f32_32x32x16_bf16 v[70:85], a[204:207], a[132:135], v[70:85]
    ds_read_b64_tr_b16 a[192:193], v92 offset:20480
    ds_read_b64_tr_b16 a[194:195], v92 offset:20992
    s_mov_b32 s98, 12591104
    buffer_load_dwordx4 a[184:187], v14, s[36:39], s98 offen offset:0 sc1
    v_mfma_f32_32x32x16_bf16 v[54:69], a[200:203], a[132:135], v[54:69]
    ds_read_b64_tr_b16 a[196:197], v93 offset:20480
    ds_read_b64_tr_b16 a[198:199], v93 offset:20992
    buffer_load_dwordx4 a[188:191], v14, s[36:39], s98 offen offset:2048 sc1
    s_waitcnt vmcnt(21) lgkmcnt(8)
    s_nop 0
    v_mfma_f32_32x32x16_bf16 v[70:85], a[212:215], a[136:139], v[70:85]
    ds_read_b64_tr_b16 a[200:201], v92 offset:24576
    ds_read_b64_tr_b16 a[202:203], v92 offset:25088
    s_mov_b32 s98, 12595200
    buffer_load_dwordx4 a[0:3], v14, s[36:39], s98 offen offset:0 sc1
    v_mfma_f32_32x32x16_bf16 v[54:69], a[208:211], a[136:139], v[54:69]
    ds_read_b64_tr_b16 a[204:205], v93 offset:24576
    ds_read_b64_tr_b16 a[206:207], v93 offset:25088
    s_barrier
    s_waitcnt vmcnt(16) lgkmcnt(8)
    v_mfma_f32_32x32x16_bf16 v[70:85], a[220:223], a[140:143], v[70:85]
    ds_read_b64_tr_b16 a[208:209], v92 offset:28672
    ds_read_b64_tr_b16 a[210:211], v92 offset:29184
    s_cmp_lg_u32 s48, 3
    s_cbranch_scc1 Lpi55
    s_load_dword s69, s[36:37], s57 offset:144 glc
Lpi55:
    s_mov_b32 s98, 12599296
    buffer_load_dwordx4 a[4:7], v14, s[36:39], s98 offen offset:0 sc1
    v_mfma_f32_32x32x16_bf16 v[54:69], a[216:219], a[140:143], v[54:69]
    ds_read_b64_tr_b16 a[212:213], v93 offset:28672
    ds_read_b64_tr_b16 a[214:215], v93 offset:29184
    buffer_load_dwordx4 a[8:11], v14, s[36:39], s98 offen offset:2048 sc1
    s_waitcnt vmcnt(17) lgkmcnt(8)
    s_nop 0
    v_mfma_f32_32x32x16_bf16 v[70:85], a[196:199], a[144:147], v[70:85]
    ds_read_b64_tr_b16 a[216:217], v92 offset:32768
    ds_read_b64_tr_b16 a[218:219], v92 offset:33280
    s_mov_b32 s98, 12603392
    v_mfma_f32_32x32x16_bf16 v[54:69], a[192:195], a[144:147], v[54:69]
    ds_read_b64_tr_b16 a[220:221], v93 offset:32768
    ds_read_b64_tr_b16 a[222:223], v93 offset:33280
    buffer_load_dwordx4 a[12:15], v14, s[36:39], s98 offen offset:0 sc1
    s_waitcnt vmcnt(17) lgkmcnt(8)
    s_nop 0
    v_mfma_f32_32x32x16_bf16 v[70:85], a[204:207], a[148:151], v[70:85]
    ds_read_b64_tr_b16 a[192:193], v92 offset:36864
    ds_read_b64_tr_b16 a[194:195], v92 offset:37376
    buffer_load_dwordx4 a[16:19], v14, s[36:39], s98 offen offset:2048 sc1
    v_mfma_f32_32x32x16_bf16 v[54:69], a[200:203], a[148:151], v[54:69]
    ds_read_b64_tr_b16 a[196:197], v93 offset:36864
    ds_read_b64_tr_b16 a[198:199], v93 offset:37376
    s_mov_b32 s98, 12607488
    buffer_load_dwordx4 a[20:23], v14, s[36:39], s98 offen offset:0 sc1
    s_waitcnt vmcnt(18) lgkmcnt(8)
    s_nop 0
    v_mfma_f32_32x32x16_bf16 v[70:85], a[212:215], a[152:155], v[70:85]
    ds_read_b64_tr_b16 a[200:201], v92 offset:40960
    ds_read_b64_tr_b16 a[202:203], v92 offset:41472
    buffer_load_dwordx4 a[24:27], v14, s[36:39], s98 offen offset:2048 sc1
    v_mfma_f32_32x32x16_bf16 v[54:69], a[208:211], a[152:155], v[54:69]
    ds_read_b64_tr_b16 a[204:205], v93 offset:40960
    ds_read_b64_tr_b16 a[206:207], v93 offset:41472
    s_mov_b32 s98, 12611584
    s_waitcnt vmcnt(18) lgkmcnt(8)
    s_nop 0
    v_mfma_f32_32x32x16_bf16 v[70:85], a[220:223], a[156:159], v[70:85]
    ds_read_b64_tr_b16 a[208:209], v92 offset:45056
    ds_read_b64_tr_b16 a[210:211], v92 offset:45568
    buffer_load_dwordx4 a[28:31], v14, s[36:39], s98 offen offset:0 sc1
    s_mov_b32 s82, 14680064
    v_mfma_f32_32x32x16_bf16 v[54:69], a[216:219], a[156:159], v[54:69]
    ds_read_b64_tr_b16 a[212:213], v93 offset:45056
    ds_read_b64_tr_b16 a[214:215], v93 offset:45568
    buffer_load_dwordx4 v[120:123], v27, s[36:39], s82 offen offset:0 sc1
    s_waitcnt vmcnt(19) lgkmcnt(8)
    s_nop 0
    v_mfma_f32_32x32x16_bf16 v[70:85], a[196:199], a[160:163], v[70:85]
    ds_read_b64_tr_b16 a[216:217], v92 offset:49152
    ds_read_b64_tr_b16 a[218:219], v92 offset:49664
    buffer_load_dwordx4 v[124:127], v27, s[36:39], s82 offen offset:512 sc1
    v_mfma_f32_32x32x16_bf16 v[54:69], a[192:195], a[160:163], v[54:69]
    ds_read_b64_tr_b16 a[220:221], v93 offset:49152
    ds_read_b64_tr_b16 a[222:223], v93 offset:49664
    s_cmp_lg_u32 s48, 3
    s_cbranch_scc1 Lpolld57
    s_waitcnt lgkmcnt(0)
    s_cmp_lt_u32 s69, 1
    s_cbranch_scc1 Lpoll56
Lpolld57:
    s_waitcnt vmcnt(17)
    s_barrier
    s_waitcnt vmcnt(16) lgkmcnt(8)
    v_mfma_f32_32x32x16_bf16 v[70:85], a[204:207], a[164:167], v[70:85]
    ds_read_b64_tr_b16 a[192:193], v92 offset:4096
    ds_read_b64_tr_b16 a[194:195], v92 offset:4608
    buffer_load_dwordx4 v[112:115], v26, s[32:35], 0 offen offset:0 sc1
    v_mfma_f32_32x32x16_bf16 v[54:69], a[200:203], a[164:167], v[54:69]
    ds_read_b64_tr_b16 a[196:197], v93 offset:4096
    ds_read_b64_tr_b16 a[198:199], v93 offset:4608
    buffer_load_dwordx4 v[116:119], v26, s[32:35], 0 offen offset:1024 sc1
    s_waitcnt vmcnt(17) lgkmcnt(8)
    s_nop 0
    v_mfma_f32_32x32x16_bf16 v[70:85], a[212:215], a[168:171], v[70:85]
    ds_read_b64_tr_b16 a[200:201], v92 offset:8192
    ds_read_b64_tr_b16 a[202:203], v92 offset:8704
    v_mfma_f32_32x32x16_bf16 v[54:69], a[208:211], a[168:171], v[54:69]
    ds_read_b64_tr_b16 a[204:205], v93 offset:8192
    ds_read_b64_tr_b16 a[206:207], v93 offset:8704
    s_waitcnt vmcnt(16) lgkmcnt(8)
    s_nop 0
    v_mfma_f32_32x32x16_bf16 v[70:85], a[220:223], a[172:175], v[70:85]
    ds_read_b64_tr_b16 a[208:209], v92 offset:12288
    ds_read_b64_tr_b16 a[210:211], v92 offset:12800
    v_mfma_f32_32x32x16_bf16 v[54:69], a[216:219], a[172:175], v[54:69]
    ds_read_b64_tr_b16 a[212:213], v93 offset:12288
    ds_read_b64_tr_b16 a[214:215], v93 offset:12800
    s_waitcnt vmcnt(15) lgkmcnt(8)
    s_nop 0
    v_mfma_f32_32x32x16_bf16 v[70:85], a[196:199], a[176:179], v[70:85]
    ds_read_b64_tr_b16 a[216:217], v92 offset:16384
    ds_read_b64_tr_b16 a[218:219], v92 offset:16896
    v_mfma_f32_32x32x16_bf16 v[54:69], a[192:195], a[176:179], v[54:69]
    ds_read_b64_tr_b16 a[220:221], v93 offset:16384
    ds_read_b64_tr_b16 a[222:223], v93 offset:16896
    s_waitcnt vmcnt(14) lgkmcnt(8)
    s_nop 0
    v_mfma_f32_32x32x16_bf16 v[70:85], a[204:207], a[180:183], v[70:85]
    ds_read_b64_tr_b16 a[192:193], v94 offset:28672
    ds_read_b64_tr_b16 a[194:195], v94 offset:29184
    v_mfma_f32_32x32x16_bf16 v[54:69], a[200:203], a[180:183], v[54:69]
    ds_read_b64_tr_b16 a[196:197], v95 offset:28672
    ds_read_b64_tr_b16 a[198:199], v95 offset:29184
    s_waitcnt vmcnt(13) lgkmcnt(8)
    s_nop 0
    v_mfma_f32_32x32x16_bf16 v[70:85], a[212:215], a[184:187], v[70:85]
    ds_read_b64_tr_b16 a[200:201], v90 offset:0
    ds_read_b64_tr_b16 a[202:203], v90 offset:512
    v_mfma_f32_32x32x16_bf16 v[54:69], a[208:211], a[184:187], v[54:69]
    ds_read_b64_tr_b16 a[204:205], v91 offset:0
    ds_read_b64_tr_b16 a[206:207], v91 offset:512
    s_waitcnt vmcnt(12) lgkmcnt(8)
    s_nop 0
    v_mfma_f32_32x32x16_bf16 v[70:85], a[220:223], a[188:191], v[70:85]
    ds_read_b64_tr_b16 a[208:209], v90 offset:4096
    ds_read_b64_tr_b16 a[210:211], v90 offset:4608
    v_mfma_f32_32x32x16_bf16 v[54:69], a[216:219], a[188:191], v[54:69]
    ds_read_b64_tr_b16 a[212:213], v91 offset:4096
    ds_read_b64_tr_b16 a[214:215], v91 offset:4608
    s_waitcnt vmcnt(11) lgkmcnt(8)
    s_nop 0
    v_mfma_f32_32x32x16_bf16 v[70:85], a[196:199], a[0:3], v[70:85]
    ds_read_b64_tr_b16 a[216:217], v90 offset:8192
    ds_read_b64_tr_b16 a[218:219], v90 offset:8704
    v_mfma_f32_32x32x16_bf16 v[54:69], a[192:195], a[0:3], v[54:69]
    ds_read_b64_tr_b16 a[220:221], v91 offset:8192
    ds_read_b64_tr_b16 a[222:223], v91 offset:8704
    s_waitcnt vmcnt(10) lgkmcnt(8)
    s_nop 0
    v_mfma_f32_32x32x16_bf16 v[70:85], a[204:207], a[4:7], v[70:85]
    ds_read_b64_tr_b16 a[192:193], v90 offset:12288
    ds_read_b64_tr_b16 a[194:195], v90 offset:12800
    v_mfma_f32_32x32x16_bf16 v[54:69], a[200:203], a[4:7], v[54:69]
    ds_read_b64_tr_b16 a[196:197], v91 offset:12288
    ds_read_b64_tr_b16 a[198:199], v91 offset:12800
    s_waitcnt vmcnt(9) lgkmcnt(8)
    s_nop 0
    v_mfma_f32_32x32x16_bf16 v[70:85], a[212:215], a[8:11], v[70:85]
    ds_read_b64_tr_b16 a[200:201], v90 offset:16384
    ds_read_b64_tr_b16 a[202:203], v90 offset:16896
    v_mfma_f32_32x32x16_bf16 v[54:69], a[208:211], a[8:11], v[54:69]
    ds_read_b64_tr_b16 a[204:205], v91 offset:16384
    ds_read_b64_tr_b16 a[206:207], v91 offset:16896
    s_waitcnt vmcnt(8) lgkmcnt(8)
    s_nop 0
    v_mfma_f32_32x32x16_bf16 v[70:85], a[220:223], a[12:15], v[70:85]
    ds_read_b64_tr_b16 a[208:209], v90 offset:20480
    ds_read_b64_tr_b16 a[210:211], v90 offset:20992
    v_mfma_f32_32x32x16_bf16 v[54:69], a[216:219], a[12:15], v[54:69]
    ds_read_b64_tr_b16 a[212:213], v91 offset:20480
    ds_read_b64_tr_b16 a[214:215], v91 offset:20992
    s_waitcnt vmcnt(2)
    v_lshlrev_b32 v208, 16, v120
    v_and_b32 v209, 0xffff0000, v120
    v_lshlrev_b32_e64 v210, 16, v121
    v_and_b32 v211, 0xffff0000, v121
    s_waitcnt lgkmcnt(8)
    s_nop 0
    v_mfma_f32_32x32x16_bf16 v[70:85], a[196:199], a[16:19], v[70:85]
    ds_read_b64_tr_b16 a[216:217], v90 offset:24576
    ds_read_b64_tr_b16 a[218:219], v90 offset:25088
    v_lshlrev_b32_e64 v212, 16, v122
    v_and_b32 v213, 0xffff0000, v122
    v_lshlrev_b32_e64 v214, 16, v123
    v_and_b32 v215, 0xffff0000, v123
    v_lshlrev_b32_e64 v216, 16, v124
    v_mfma_f32_32x32x16_bf16 v[54:69], a[192:195], a[16:19], v[54:69]
    ds_read_b64_tr_b16 a[220:221], v91 offset:24576
    ds_read_b64_tr_b16 a[222:223], v91 offset:25088
    v_and_b32 v217, 0xffff0000, v124
    v_lshlrev_b32_e64 v218, 16, v125
    v_and_b32 v219, 0xffff0000, v125
    v_lshlrev_b32_e64 v220, 16, v126
    v_and_b32 v221, 0xffff0000, v126
    s_waitcnt lgkmcnt(8)
    v_mfma_f32_32x32x16_bf16 v[70:85], a[204:207], a[20:23], v[70:85]
    v_lshlrev_b32 v222, 16, v127
    v_and_b32 v223, 0xffff0000, v127
    s_waitcnt vmcnt(0)
    v_lshlrev_b32 v192, 16, v112
    v_and_b32 v193, 0xffff0000, v112
    s_waitcnt lgkmcnt(4)
    v_mfma_f32_32x32x16_bf16 v[70:85], a[212:215], a[24:27], v[70:85]
    v_lshlrev_b32 v194, 16, v113
    v_and_b32 v195, 0xffff0000, v113
    v_lshlrev_b32_e64 v196, 16, v114
    v_and_b32 v197, 0xffff0000, v114
    v_lshlrev_b32 v198, 16, v115
    s_waitcnt lgkmcnt(0)
    v_mfma_f32_32x32x16_bf16 v[70:85], a[220:223], a[28:31], v[70:85]
    v_and_b32 v199, 0xffff0000, v115
    v_lshlrev_b32_e64 v200, 16, v116
    v_and_b32 v201, 0xffff0000, v116
    v_lshlrev_b32_e64 v202, 16, v117
    v_and_b32 v203, 0xffff0000, v117
    v_mfma_f32_32x32x16_bf16 v[54:69], a[200:203], a[20:23], v[54:69]
    v_lshlrev_b32_e64 v204, 16, v118
    v_and_b32 v205, 0xffff0000, v118
    v_lshlrev_b32_e64 v206, 16, v119
    v_and_b32 v207, 0xffff0000, v119
    v_mfma_f32_32x32x16_bf16 v[54:69], a[208:211], a[24:27], v[54:69]
    s_nop 0
    s_nop 0
    ds_write_b128 v104, v[70:73] offset:0
    ds_write_b128 v104, v[74:77] offset:1024
    v_mfma_f32_32x32x16_bf16 v[54:69], a[216:219], a[28:31], v[54:69]
    ds_write_b128 v104, v[78:81] offset:2048
    ds_write_b128 v104, v[82:85] offset:3072
    s_waitcnt lgkmcnt(0)
    s_barrier
    ds_read_b128 v[160:163], v105 offset:0
    ds_read_b128 v[164:167], v105 offset:1024
    ds_read_b128 v[168:171], v105 offset:2048
    ds_read_b128 v[172:175], v105 offset:3072
    v_pk_add_f32 v[192:193], v[192:193], v[208:209]
    v_pk_add_f32 v[194:195], v[194:195], v[210:211]
    v_pk_add_f32 v[196:197], v[196:197], v[212:213]
    v_pk_add_f32 v[198:199], v[198:199], v[214:215]
    v_pk_add_f32 v[200:201], v[200:201], v[216:217]
    v_pk_add_f32 v[202:203], v[202:203], v[218:219]
    v_pk_add_f32 v[204:205], v[204:205], v[220:221]
    v_pk_add_f32 v[206:207], v[206:207], v[222:223]
    v_pk_add_f32 v[54:55], v[54:55], v[192:193]
    v_pk_add_f32 v[56:57], v[56:57], v[194:195]
    v_pk_add_f32 v[58:59], v[58:59], v[196:197]
    v_pk_add_f32 v[60:61], v[60:61], v[198:199]
    v_pk_add_f32 v[62:63], v[62:63], v[200:201]
    v_pk_add_f32 v[64:65], v[64:65], v[202:203]
    v_pk_add_f32 v[66:67], v[66:67], v[204:205]
    v_pk_add_f32 v[68:69], v[68:69], v[206:207]
    s_waitcnt lgkmcnt(3)
    s_nop 0
    v_pk_add_f32 v[54:55], v[54:55], v[160:161]
    v_cvt_pk_bf16_f32 v176, v54, v55
    v_pk_add_f32 v[56:57], v[56:57], v[162:163]
    v_cvt_pk_bf16_f32 v177, v56, v57
    s_waitcnt lgkmcnt(2)
    s_nop 0
    v_pk_add_f32 v[58:59], v[58:59], v[164:165]
    v_cvt_pk_bf16_f32 v178, v58, v59
    v_pk_add_f32 v[60:61], v[60:61], v[166:167]
    v_cvt_pk_bf16_f32 v179, v60, v61
    buffer_store_dwordx4 v[176:179], v88, s[32:35], 0 offen offset:0
    s_waitcnt lgkmcnt(1)
    s_nop 0
    v_pk_add_f32 v[62:63], v[62:63], v[168:169]
    v_cvt_pk_bf16_f32 v180, v62, v63
    v_pk_add_f32 v[64:65], v[64:65], v[170:171]
    v_cvt_pk_bf16_f32 v181, v64, v65
    s_waitcnt lgkmcnt(0)
    s_nop 0
    v_pk_add_f32 v[66:67], v[66:67], v[172:173]
    v_cvt_pk_bf16_f32 v182, v66, v67
    v_pk_add_f32 v[68:69], v[68:69], v[174:175]
    v_cvt_pk_bf16_f32 v183, v68, v69
    buffer_store_dwordx4 v[180:183], v88, s[32:35], 0 offen offset:16
    s_endpgm
Lt22:
    s_bfm_b64 exec, 16, 0
    buffer_load_dword v13, v0, s[20:23], s52 offen
    s_bfm_b64 exec, 28, 0
    buffer_load_dword v13, v12, s[24:27], s51 offen
    s_mov_b64 exec, -1
    s_branch Lt2b3
Lt24:
    s_bfm_b64 exec, 16, 0
    buffer_load_dword v13, v0, s[20:23], s52 offen
    s_bfm_b64 exec, 28, 0
    buffer_load_dword v13, v12, s[24:27], s51 offen
    s_mov_b64 exec, -1
    s_branch Lt2b5
Lpoll6:
    s_mov_b32 s55, 200000
Lpoll6x:
    s_sleep 2
    s_sub_u32 s55, s55, 1
    s_cbranch_scc1 Lpolld7
    s_load_dword s69, s[40:41], 0 glc
    s_waitcnt lgkmcnt(0)
    s_cmp_lt_u32 s69, 1
    s_cbranch_scc1 Lpoll6x
    s_branch Lpolld7
Lt29:
    s_bfm_b64 exec, 16, 0
    buffer_load_dword v13, v0, s[20:23], s52 offen
    s_bfm_b64 exec, 28, 0
    buffer_load_dword v13, v12, s[24:27], s51 offen
    s_mov_b64 exec, -1
    s_branch Lt2b10
Lt211:
    s_bfm_b64 exec, 16, 0
    buffer_load_dword v13, v0, s[20:23], s52 offen
    s_bfm_b64 exec, 28, 0
    buffer_load_dword v13, v12, s[24:27], s51 offen
    s_mov_b64 exec, -1
    s_branch Lt2b12
Lt213:
    s_bfm_b64 exec, 16, 0
    buffer_load_dword v13, v0, s[20:23], s52 offen
    s_bfm_b64 exec, 8, 0
    buffer_load_dword v13, v12, s[12:15], s50 offen
    s_bfm_b64 exec, 28, 0
    buffer_load_dword v13, v12, s[28:31], s51 offen
    s_mov_b64 exec, -1
    s_branch Lt2b14
Lt215:
    s_bfm_b64 exec, 16, 0
    buffer_load_dword v13, v0, s[20:23], s52 offen
    s_bfm_b64 exec, 8, 0
    buffer_load_dword v13, v12, s[12:15], s50 offen
    s_bfm_b64 exec, 28, 0
    buffer_load_dword v13, v12, s[28:31], s51 offen
    s_mov_b64 exec, -1
    s_branch Lt2b16
Lt217:
    s_bfm_b64 exec, 16, 0
    buffer_load_dword v13, v0, s[20:23], s52 offen
    s_bfm_b64 exec, 8, 0
    buffer_load_dword v13, v12, s[12:15], s50 offen
    s_bfm_b64 exec, 28, 0
    buffer_load_dword v13, v12, s[28:31], s51 offen
    s_mov_b64 exec, -1
    s_branch Lt2b18
Lt219:
    s_bfm_b64 exec, 16, 0
    buffer_load_dword v13, v0, s[20:23], s52 offen
    s_bfm_b64 exec, 8, 0
    buffer_load_dword v13, v12, s[12:15], s50 offen
    s_bfm_b64 exec, 28, 0
    buffer_load_dword v13, v12, s[28:31], s51 offen
    s_mov_b64 exec, -1
    s_branch Lt2b20
Lpoll22:
    s_mov_b32 s55, 200000
Lpoll22x:
    s_sleep 2
    s_sub_u32 s55, s55, 1
    s_cbranch_scc1 Lpolld23
    s_load_dword s69, s[36:37], s64 offset:132 glc
    s_load_dword s70, s[36:37], s65 offset:132 glc
    s_load_dword s71, s[36:37], s66 offset:132 glc
    s_waitcnt lgkmcnt(0)
    s_min_u32 s69, s69, s70
    s_min_u32 s69, s69, s71
    s_cmp_lt_u32 s69, 8
    s_cbranch_scc1 Lpoll22x
    s_branch Lpolld23
Lpoll26:
    s_mov_b32 s55, 200000
Lpoll26x:
    s_sleep 1
    s_sub_u32 s55, s55, 1
    s_cbranch_scc1 Lpolld27
    s_load_dword s69, s[36:37], s68 offset:260 glc
    s_waitcnt lgkmcnt(0)
    s_cmp_lt_u32 s69, 16
    s_cbranch_scc1 Lpoll26x
    s_branch Lpolld27
Lpoll30:
    s_mov_b32 s55, 200000
Lpoll30x:
    s_sleep 2
    s_sub_u32 s55, s55, 1
    s_cbranch_scc1 Lpolld31
    s_load_dword s69, s[36:37], s64 offset:0 glc
    s_waitcnt lgkmcnt(0)
    s_cmp_lt_u32 s69, 8
    s_cbranch_scc1 Lpoll30x
    s_branch Lpolld31
Lpoll34:
    s_mov_b32 s55, 200000
Lpoll34x:
    s_sleep 2
    s_sub_u32 s55, s55, 1
    s_cbranch_scc1 Lpolld35
    s_load_dword s69, s[36:37], s64 offset:128 glc
    s_waitcnt lgkmcnt(0)
    s_cmp_lt_u32 s69, 7
    s_cbranch_scc1 Lpoll34x
    s_branch Lpolld35
Lpoll38:
    s_mov_b32 s55, 200000
Lpoll38x:
    s_sleep 2
    s_sub_u32 s55, s55, 1
    s_cbranch_scc1 Lpolld39
    s_load_dword s69, s[36:37], s64 offset:0 glc
    s_load_dword s70, s[36:37], s65 offset:0 glc
    s_waitcnt lgkmcnt(0)
    s_min_u32 s69, s69, s70
    s_cmp_lt_u32 s69, 8
    s_cbranch_scc1 Lpoll38x
    s_branch Lpolld39
Lpoll41:
    s_mov_b32 s55, 200000
Lpoll41x:
    s_sleep 2
    s_sub_u32 s55, s55, 1
    s_cbranch_scc1 Lpolld42
    s_load_dword s69, s[36:37], s64 offset:128 glc
    s_waitcnt lgkmcnt(0)
    s_cmp_lt_u32 s69, 7
    s_cbranch_scc1 Lpoll41x
    s_branch Lpolld42
Lidle1:
    v_and_b32 v18, 0x7fffffff, v18
    v_subrev_u32 v18, 4194304, v18
    s_and_b32 s81, s2, 1
    s_mul_i32 s81, s81, 14336
    s_add_u32 s81, s81, 18845696
    v_and_b32 v4, 0x7fffffff, v31
    v_add_u32_e64 v4, s81, v4
    v_add_u32 v98, 81920, v96
    v_add_u32 v99, 81920, v97
    s_add_u32 m0, s54, 65536
    s_nop 0
    s_nop 0
    buffer_load_dwordx4 v2, s[12:15], s53 offen lds
    s_add_u32 m0, s54, 69632
    s_add_u32 s80, s53, 32768
    buffer_load_dwordx4 v2, s[12:15], s80 offen lds
    s_add_u32 m0, s54, 73728
    s_add_u32 s80, s53, 65536
    buffer_load_dwordx4 v2, s[12:15], s80 offen lds
    s_add_u32 m0, s54, 77824
    s_add_u32 s80, s53, 98304
    buffer_load_dwordx4 v2, s[12:15], s80 offen lds
    s_add_u32 m0, s54, 151552
    s_nop 0
    s_nop 0
    buffer_load_dwordx4 v2, s[28:31], s99 offen lds
    s_add_u32 m0, s54, 147456
    s_add_u32 s80, s99, 557056
    buffer_load_dwordx4 v2, s[28:31], s80 offen lds
    s_mov_b32 s80, 589824
    buffer_load_dwordx4 v[112:115], v2, s[28:31], s80 offen
    s_mov_b32 s80, 720896
    buffer_load_dwordx4 v[116:119], v2, s[28:31], s80 offen
    s_cmp_lg_u32 s48, 3
    s_cbranch_scc1 Lpi37
    s_load_dword s69, s[36:37], s64 offset:0 glc
    s_load_dword s70, s[36:37], s65 offset:0 glc
Lpi37:
    s_cmp_lg_u32 s48, 3
    s_cbranch_scc1 Lpolld39
    s_waitcnt lgkmcnt(0)
    s_min_u32 s69, s69, s70
    s_cmp_lt_u32 s69, 8
    s_cbranch_scc1 Lpoll38
Lpolld39:
    s_barrier
    s_nop 0
    s_mov_b32 s98, 2105344
    buffer_load_dwordx4 a[64:67], v18, s[36:39], s98 offen offset:0 sc1
    buffer_load_dwordx4 a[68:71], v18, s[36:39], s98 offen offset:1024 sc1
    buffer_load_dwordx4 a[72:75], v18, s[36:39], s98 offen offset:2048 sc1
    buffer_load_dwordx4 a[76:79], v18, s[36:39], s98 offen offset:3072 sc1
    s_mov_b32 s98, 2109440
    buffer_load_dwordx4 a[80:83], v18, s[36:39], s98 offen offset:0 sc1
    buffer_load_dwordx4 a[84:87], v18, s[36:39], s98 offen offset:1024 sc1
    buffer_load_dwordx4 a[88:91], v18, s[36:39], s98 offen offset:2048 sc1
    buffer_load_dwordx4 a[92:95], v18, s[36:39], s98 offen offset:3072 sc1
    s_mov_b32 s98, 2121728
    buffer_load_dwordx4 a[96:99], v18, s[36:39], s98 offen offset:0 sc1
    buffer_load_dwordx4 a[100:103], v18, s[36:39], s98 offen offset:1024 sc1
    ds_read_b64_tr_b16 a[192:193], v96 offset:0
    ds_read_b64_tr_b16 a[194:195], v96 offset:512
    ds_read_b64_tr_b16 a[196:197], v97 offset:0
    ds_read_b64_tr_b16 a[198:199], v97 offset:512
    ds_read_b64_tr_b16 a[200:201], v96 offset:32768
    ds_read_b64_tr_b16 a[202:203], v96 offset:33280
    ds_read_b64_tr_b16 a[204:205], v96 offset:2048
    ds_read_b64_tr_b16 a[206:207], v96 offset:2560
    ds_read_b64_tr_b16 a[208:209], v97 offset:2048
    ds_read_b64_tr_b16 a[210:211], v97 offset:2560
    ds_read_b64_tr_b16 a[212:213], v96 offset:34816
    ds_read_b64_tr_b16 a[214:215], v96 offset:35328
    s_waitcnt vmcnt(9) lgkmcnt(8)
    s_nop 0
    v_mfma_f32_32x32x16_bf16 v[128:143], a[192:195], a[64:67], 0
    ds_read_b64_tr_b16 a[216:217], v96 offset:4096
    ds_read_b64_tr_b16 a[218:219], v96 offset:4608
    v_mfma_f32_32x32x16_bf16 v[144:159], a[196:199], a[64:67], 0
    ds_read_b64_tr_b16 a[220:221], v97 offset:4096
    ds_read_b64_tr_b16 a[222:223], v97 offset:4608
    buffer_load_dwordx4 a[104:107], v18, s[36:39], s98 offen offset:2048 sc1
    s_waitcnt lgkmcnt(8)
    s_nop 0
    v_mfma_f32_32x32x16_bf16 v[160:175], a[200:203], a[64:67], 0
    ds_read_b64_tr_b16 a[192:193], v96 offset:36864
    ds_read_b64_tr_b16 a[194:195], v96 offset:37376
    s_waitcnt vmcnt(9)
    s_nop 0
    v_mfma_f32_32x32x16_bf16 v[128:143], a[204:207], a[68:71], v[128:143]
    ds_read_b64_tr_b16 a[196:197], v96 offset:6144
    ds_read_b64_tr_b16 a[198:199], v96 offset:6656
    buffer_load_dwordx4 a[108:111], v18, s[36:39], s98 offen offset:3072 sc1
    s_waitcnt lgkmcnt(8)
    s_nop 0
    v_mfma_f32_32x32x16_bf16 v[144:159], a[208:211], a[68:71], v[144:159]
    ds_read_b64_tr_b16 a[200:201], v97 offset:6144
    ds_read_b64_tr_b16 a[202:203], v97 offset:6656
    s_mov_b32 s98, 2125824
    v_mfma_f32_32x32x16_bf16 v[160:175], a[212:215], a[68:71], v[160:175]
    ds_read_b64_tr_b16 a[204:205], v96 offset:38912
    ds_read_b64_tr_b16 a[206:207], v96 offset:39424
    buffer_load_dwordx4 a[112:115], v18, s[36:39], s98 offen offset:0 sc1
    s_waitcnt vmcnt(10) lgkmcnt(8)
    s_nop 0
    v_mfma_f32_32x32x16_bf16 v[128:143], a[216:219], a[72:75], v[128:143]
    ds_read_b64_tr_b16 a[208:209], v96 offset:8192
    ds_read_b64_tr_b16 a[210:211], v96 offset:8704
    v_mfma_f32_32x32x16_bf16 v[144:159], a[220:223], a[72:75], v[144:159]
    ds_read_b64_tr_b16 a[212:213], v97 offset:8192
    ds_read_b64_tr_b16 a[214:215], v97 offset:8704
    s_waitcnt lgkmcnt(8)
    s_nop 0
    v_mfma_f32_32x32x16_bf16 v[160:175], a[192:195], a[72:75], v[160:175]
    ds_read_b64_tr_b16 a[216:217], v96 offset:40960
    ds_read_b64_tr_b16 a[218:219], v96 offset:41472
    buffer_load_dwordx4 a[116:119], v18, s[36:39], s98 offen offset:1024 sc1
    s_waitcnt vmcnt(10)
    s_nop 0
    v_mfma_f32_32x32x16_bf16 v[128:143], a[196:199], a[76:79], v[128:143]
    ds_read_b64_tr_b16 a[220:221], v96 offset:10240
    ds_read_b64_tr_b16 a[222:223], v96 offset:10752
    s_waitcnt lgkmcnt(8)
    s_nop 0
    v_mfma_f32_32x32x16_bf16 v[144:159], a[200:203], a[76:79], v[144:159]
    ds_read_b64_tr_b16 a[192:193], v97 offset:10240
    ds_read_b64_tr_b16 a[194:195], v97 offset:10752
    buffer_load_dwordx4 a[120:123], v18, s[36:39], s98 offen offset:2048 sc1
    v_mfma_f32_32x32x16_bf16 v[160:175], a[204:207], a[76:79], v[160:175]
    ds_read_b64_tr_b16 a[196:197], v96 offset:43008
    ds_read_b64_tr_b16 a[198:199], v96 offset:43520
    s_waitcnt vmcnt(10) lgkmcnt(8)
    s_nop 0
    v_mfma_f32_32x32x16_bf16 v[128:143], a[208:211], a[80:83], v[128:143]
    ds_read_b64_tr_b16 a[200:201], v96 offset:12288
    ds_read_b64_tr_b16 a[202:203], v96 offset:12800
    buffer_load_dwordx4 a[124:127], v18, s[36:39], s98 offen offset:3072 sc1
    v_mfma_f32_32x32x16_bf16 v[144:159], a[212:215], a[80:83], v[144:159]
    ds_read_b64_tr_b16 a[204:205], v97 offset:12288
    ds_read_b64_tr_b16 a[206:207], v97 offset:12800
    s_mov_b32 s98, 2097152
    s_waitcnt lgkmcnt(8)
    s_nop 0
    v_mfma_f32_32x32x16_bf16 v[160:175], a[216:219], a[80:83], v[160:175]
    ds_read_b64_tr_b16 a[208:209], v96 offset:45056
    ds_read_b64_tr_b16 a[210:211], v96 offset:45568
    s_waitcnt vmcnt(10)
    s_nop 0
    v_mfma_f32_32x32x16_bf16 v[128:143], a[220:223], a[84:87], v[128:143]
    ds_read_b64_tr_b16 a[212:213], v96 offset:14336
    ds_read_b64_tr_b16 a[214:215], v96 offset:14848
    buffer_load_dwordx4 a[0:3], v20, s[36:39], s98 offen offset:0 sc1
    s_waitcnt lgkmcnt(8)
    s_nop 0
    v_mfma_f32_32x32x16_bf16 v[144:159], a[192:195], a[84:87], v[144:159]
    ds_read_b64_tr_b16 a[216:217], v97 offset:14336
    ds_read_b64_tr_b16 a[218:219], v97 offset:14848
    v_mfma_f32_32x32x16_bf16 v[160:175], a[196:199], a[84:87], v[160:175]
    ds_read_b64_tr_b16 a[220:221], v96 offset:47104
    ds_read_b64_tr_b16 a[222:223], v96 offset:47616
    buffer_load_dwordx4 a[4:7], v21, s[36:39], s98 offen offset:0 sc1
    s_waitcnt vmcnt(11) lgkmcnt(8)
    s_nop 0
    v_mfma_f32_32x32x16_bf16 v[128:143], a[200:203], a[88:91], v[128:143]
    ds_read_b64_tr_b16 a[192:193], v96 offset:16384
    ds_read_b64_tr_b16 a[194:195], v96 offset:16896
    v_mfma_f32_32x32x16_bf16 v[144:159], a[204:207], a[88:91], v[144:159]
    ds_read_b64_tr_b16 a[196:197], v97 offset:16384
    ds_read_b64_tr_b16 a[198:199], v97 offset:16896
    buffer_load_dwordx4 a[8:11], v20, s[36:39], s98 offen offset:2048 sc1
    s_waitcnt lgkmcnt(8)
    s_nop 0
    v_mfma_f32_32x32x16_bf16 v[160:175], a[208:211], a[88:91], v[160:175]
    ds_read_b64_tr_b16 a[200:201], v96 offset:49152
    ds_read_b64_tr_b16 a[202:203], v96 offset:49664
    s_waitcnt vmcnt(11)
    s_nop 0
    v_mfma_f32_32x32x16_bf16 v[128:143], a[212:215], a[92:95], v[128:143]
    ds_read_b64_tr_b16 a[204:205], v96 offset:18432
    ds_read_b64_tr_b16 a[206:207], v96 offset:18944
    buffer_load_dwordx4 a[12:15], v21, s[36:39], s98 offen offset:2048 sc1
    s_waitcnt lgkmcnt(8)
    s_nop 0
    v_mfma_f32_32x32x16_bf16 v[144:159], a[216:219], a[92:95], v[144:159]
    ds_read_b64_tr_b16 a[208:209], v97 offset:18432
    ds_read_b64_tr_b16 a[210:211], v97 offset:18944
    v_mfma_f32_32x32x16_bf16 v[160:175], a[220:223], a[92:95], v[160:175]
    ds_read_b64_tr_b16 a[212:213], v96 offset:51200
    ds_read_b64_tr_b16 a[214:215], v96 offset:51712
    s_mov_b32 s98, 2101248
    s_waitcnt vmcnt(11) lgkmcnt(8)
    s_nop 0
    v_mfma_f32_32x32x16_bf16 v[128:143], a[192:195], a[96:99], v[128:143]
    ds_read_b64_tr_b16 a[216:217], v96 offset:20480
    ds_read_b64_tr_b16 a[218:219], v96 offset:20992
    buffer_load_dwordx4 a[16:19], v20, s[36:39], s98 offen offset:0 sc1
    v_mfma_f32_32x32x16_bf16 v[144:159], a[196:199], a[96:99], v[144:159]
    ds_read_b64_tr_b16 a[220:221], v97 offset:20480
    ds_read_b64_tr_b16 a[222:223], v97 offset:20992
    s_waitcnt lgkmcnt(8)
    s_nop 0
    v_mfma_f32_32x32x16_bf16 v[160:175], a[200:203], a[96:99], v[160:175]
    ds_read_b64_tr_b16 a[192:193], v96 offset:53248
    ds_read_b64_tr_b16 a[194:195], v96 offset:53760
    buffer_load_dwordx4 a[20:23], v21, s[36:39], s98 offen offset:0 sc1
    s_waitcnt vmcnt(12)
    s_nop 0
    v_mfma_f32_32x32x16_bf16 v[128:143], a[204:207], a[100:103], v[128:143]
    ds_read_b64_tr_b16 a[196:197], v96 offset:22528
    ds_read_b64_tr_b16 a[198:199], v96 offset:23040
    s_waitcnt lgkmcnt(8)
    s_nop 0
    v_mfma_f32_32x32x16_bf16 v[144:159], a[208:211], a[100:103], v[144:159]
    ds_read_b64_tr_b16 a[200:201], v97 offset:22528
    ds_read_b64_tr_b16 a[202:203], v97 offset:23040
    buffer_load_dwordx4 a[24:27], v20, s[36:39], s98 offen offset:2048 sc1
    v_mfma_f32_32x32x16_bf16 v[160:175], a[212:215], a[100:103], v[160:175]
    ds_read_b64_tr_b16 a[204:205], v96 offset:55296
    ds_read_b64_tr_b16 a[206:207], v96 offset:55808
    s_waitcnt vmcnt(12) lgkmcnt(8)
    s_nop 0
    v_mfma_f32_32x32x16_bf16 v[128:143], a[216:219], a[104:107], v[128:143]
    ds_read_b64_tr_b16 a[208:209], v96 offset:24576
    ds_read_b64_tr_b16 a[210:211], v96 offset:25088
    v_mfma_f32_32x32x16_bf16 v[144:159], a[220:223], a[104:107], v[144:159]
    ds_read_b64_tr_b16 a[212:213], v97 offset:24576
    ds_read_b64_tr_b16 a[214:215], v97 offset:25088
    buffer_load_dwordx4 a[28:31], v21, s[36:39], s98 offen offset:2048 sc1
    s_waitcnt lgkmcnt(8)
    s_nop 0
    v_mfma_f32_32x32x16_bf16 v[160:175], a[192:195], a[104:107], v[160:175]
    ds_read_b64_tr_b16 a[216:217], v96 offset:57344
    ds_read_b64_tr_b16 a[218:219], v96 offset:57856
    s_mov_b32 s80, 851968
    s_waitcnt vmcnt(12)
    s_nop 0
    v_mfma_f32_32x32x16_bf16 v[128:143], a[196:199], a[108:111], v[128:143]
    ds_read_b64_tr_b16 a[220:221], v96 offset:26624
    ds_read_b64_tr_b16 a[222:223], v96 offset:27136
    buffer_load_dwordx4 v[120:123], v2, s[28:31], s80 offen
    s_waitcnt lgkmcnt(8)
    s_nop 0
    v_mfma_f32_32x32x16_bf16 v[144:159], a[200:203], a[108:111], v[144:159]
    ds_read_b64_tr_b16 a[192:193], v97 offset:26624
    ds_read_b64_tr_b16 a[194:195], v97 offset:27136
    s_mov_b32 s80, 983040
    v_mfma_f32_32x32x16_bf16 v[160:175], a[204:207], a[108:111], v[160:175]
    ds_read_b64_tr_b16 a[196:197], v96 offset:59392
    ds_read_b64_tr_b16 a[198:199], v96 offset:59904
    buffer_load_dwordx4 v[124:127], v2, s[28:31], s80 offen
    s_waitcnt vmcnt(13) lgkmcnt(8)
    s_nop 0
    v_mfma_f32_32x32x16_bf16 v[128:143], a[208:211], a[112:115], v[128:143]
    ds_read_b64_tr_b16 a[200:201], v96 offset:28672
    ds_read_b64_tr_b16 a[202:203], v96 offset:29184
    v_mfma_f32_32x32x16_bf16 v[144:159], a[212:215], a[112:115], v[144:159]
    ds_read_b64_tr_b16 a[204:205], v97 offset:28672
    ds_read_b64_tr_b16 a[206:207], v97 offset:29184
    s_waitcnt lgkmcnt(8)
    s_nop 0
    v_mfma_f32_32x32x16_bf16 v[160:175], a[216:219], a[112:115], v[160:175]
    ds_read_b64_tr_b16 a[208:209], v96 offset:61440
    ds_read_b64_tr_b16 a[210:211], v96 offset:61952
    s_waitcnt vmcnt(12)
    s_nop 0
    v_mfma_f32_32x32x16_bf16 v[128:143], a[220:223], a[116:119], v[128:143]
    ds_read_b64_tr_b16 a[212:213], v96 offset:30720
    ds_read_b64_tr_b16 a[214:215], v96 offset:31232
    s_waitcnt lgkmcnt(8)
    s_nop 0
    v_mfma_f32_32x32x16_bf16 v[144:159], a[192:195], a[116:119], v[144:159]
    ds_read_b64_tr_b16 a[216:217], v97 offset:30720
    ds_read_b64_tr_b16 a[218:219], v97 offset:31232
    v_mfma_f32_32x32x16_bf16 v[160:175], a[196:199], a[116:119], v[160:175]
    ds_read_b64_tr_b16 a[220:221], v96 offset:63488
    ds_read_b64_tr_b16 a[222:223], v96 offset:64000
    s_waitcnt vmcnt(11) lgkmcnt(8)
    s_nop 0
    v_mfma_f32_32x32x16_bf16 v[128:143], a[200:203], a[120:123], v[128:143]
    ds_read_b64_tr_b16 a[192:193], v97 offset:32768
    ds_read_b64_tr_b16 a[194:195], v97 offset:33280
    v_mfma_f32_32x32x16_bf16 v[144:159], a[204:207], a[120:123], v[144:159]
    ds_read_b64_tr_b16 a[196:197], v97 offset:34816
    ds_read_b64_tr_b16 a[198:199], v97 offset:35328
    s_waitcnt lgkmcnt(8)
    s_nop 0
    v_mfma_f32_32x32x16_bf16 v[160:175], a[208:211], a[120:123], v[160:175]
    ds_read_b64_tr_b16 a[200:201], v97 offset:36864
    ds_read_b64_tr_b16 a[202:203], v97 offset:37376
    s_waitcnt vmcnt(10)
    s_nop 0
    v_mfma_f32_32x32x16_bf16 v[128:143], a[212:215], a[124:127], v[128:143]
    ds_read_b64_tr_b16 a[204:205], v97 offset:38912
    ds_read_b64_tr_b16 a[206:207], v97 offset:39424
    s_waitcnt lgkmcnt(8)
    s_nop 0
    v_mfma_f32_32x32x16_bf16 v[144:159], a[216:219], a[124:127], v[144:159]
    ds_read_b64_tr_b16 a[208:209], v97 offset:40960
    ds_read_b64_tr_b16 a[210:211], v97 offset:41472
    v_mfma_f32_32x32x16_bf16 v[160:175], a[220:223], a[124:127], v[160:175]
    ds_read_b64_tr_b16 a[212:213], v97 offset:43008
    ds_read_b64_tr_b16 a[214:215], v97 offset:43520
    s_waitcnt lgkmcnt(8)
    s_nop 0
    v_mfma_f32_32x32x16_bf16 v[176:191], a[192:195], a[64:67], 0
    ds_read_b64_tr_b16 a[216:217], v97 offset:45056
    ds_read_b64_tr_b16 a[218:219], v97 offset:45568
    v_mfma_f32_32x32x16_bf16 v[176:191], a[196:199], a[68:71], v[176:191]
    ds_read_b64_tr_b16 a[220:221], v97 offset:47104
    ds_read_b64_tr_b16 a[222:223], v97 offset:47616
    s_waitcnt lgkmcnt(8)
    s_nop 0
    v_mfma_f32_32x32x16_bf16 v[176:191], a[200:203], a[72:75], v[176:191]
    ds_read_b64_tr_b16 a[192:193], v97 offset:49152
    ds_read_b64_tr_b16 a[194:195], v97 offset:49664
    v_cvt_pk_bf16_f32 v208, v128, v129
    v_cvt_pk_bf16_f32 v209, v130, v131
    v_mfma_f32_32x32x16_bf16 v[176:191], a[204:207], a[76:79], v[176:191]
    ds_read_b64_tr_b16 a[196:197], v97 offset:51200
    ds_read_b64_tr_b16 a[198:199], v97 offset:51712
    v_cvt_pk_bf16_f32 v210, v132, v133
    v_cvt_pk_bf16_f32 v211, v134, v135
    s_waitcnt lgkmcnt(8)
    s_nop 0
    v_mfma_f32_32x32x16_bf16 v[176:191], a[208:211], a[80:83], v[176:191]
    ds_read_b64_tr_b16 a[200:201], v97 offset:53248
    ds_read_b64_tr_b16 a[202:203], v97 offset:53760
    v_cvt_pk_bf16_f32 v212, v136, v137
    v_cvt_pk_bf16_f32 v213, v138, v139
    v_mfma_f32_32x32x16_bf16 v[176:191], a[212:215], a[84:87], v[176:191]
    ds_read_b64_tr_b16 a[204:205], v97 offset:55296
    ds_read_b64_tr_b16 a[206:207], v97 offset:55808
    v_cvt_pk_bf16_f32 v214, v140, v141
    v_cvt_pk_bf16_f32 v215, v142, v143
    s_waitcnt lgkmcnt(8)
    s_nop 0
    v_mfma_f32_32x32x16_bf16 v[176:191], a[216:219], a[88:91], v[176:191]
    ds_read_b64_tr_b16 a[208:209], v97 offset:57344
    ds_read_b64_tr_b16 a[210:211], v97 offset:57856
    v_cvt_pk_bf16_f32 v216, v144, v145
    v_cvt_pk_bf16_f32 v217, v146, v147
    v_mfma_f32_32x32x16_bf16 v[176:191], a[220:223], a[92:95], v[176:191]
    ds_read_b64_tr_b16 a[212:213], v97 offset:59392
    ds_read_b64_tr_b16 a[214:215], v97 offset:59904
    v_cvt_pk_bf16_f32 v218, v148, v149
    v_cvt_pk_bf16_f32 v219, v150, v151
    s_waitcnt lgkmcnt(8)
    s_nop 0
    v_mfma_f32_32x32x16_bf16 v[176:191], a[192:195], a[96:99], v[176:191]
    ds_read_b64_tr_b16 a[216:217], v97 offset:61440
    ds_read_b64_tr_b16 a[218:219], v97 offset:61952
    v_cvt_pk_bf16_f32 v220, v152, v153
    v_cvt_pk_bf16_f32 v221, v154, v155
    v_mfma_f32_32x32x16_bf16 v[176:191], a[196:199], a[100:103], v[176:191]
    ds_read_b64_tr_b16 a[220:221], v97 offset:63488
    ds_read_b64_tr_b16 a[222:223], v97 offset:64000
    v_cvt_pk_bf16_f32 v222, v156, v157
    v_cvt_pk_bf16_f32 v223, v158, v159
    s_waitcnt lgkmcnt(8)
    s_nop 0
    v_mfma_f32_32x32x16_bf16 v[176:191], a[200:203], a[104:107], v[176:191]
    ds_read_b64_tr_b16 a[192:193], v98 offset:0
    ds_read_b64_tr_b16 a[194:195], v98 offset:512
    v_cvt_pk_bf16_f32 v224, v160, v161
    v_cvt_pk_bf16_f32 v225, v162, v163
    v_mfma_f32_32x32x16_bf16 v[176:191], a[204:207], a[108:111], v[176:191]
    ds_read_b64_tr_b16 a[196:197], v98 offset:2048
    ds_read_b64_tr_b16 a[198:199], v98 offset:2560
    v_cvt_pk_bf16_f32 v226, v164, v165
    v_cvt_pk_bf16_f32 v227, v166, v167
    s_waitcnt lgkmcnt(8)
    s_nop 0
    v_mfma_f32_32x32x16_bf16 v[176:191], a[208:211], a[112:115], v[176:191]
    ds_read_b64_tr_b16 a[200:201], v98 offset:4096
    ds_read_b64_tr_b16 a[202:203], v98 offset:4608
    v_cvt_pk_bf16_f32 v228, v168, v169
    v_cvt_pk_bf16_f32 v229, v170, v171
    v_mfma_f32_32x32x16_bf16 v[176:191], a[212:215], a[116:119], v[176:191]
    ds_read_b64_tr_b16 a[204:205], v98 offset:6144
    ds_read_b64_tr_b16 a[206:207], v98 offset:6656
    v_cvt_pk_bf16_f32 v230, v172, v173
    v_cvt_pk_bf16_f32 v231, v174, v175
    s_waitcnt lgkmcnt(8)
    s_nop 0
    v_mfma_f32_32x32x16_bf16 v[176:191], a[216:219], a[120:123], v[176:191]
    ds_read_b64_tr_b16 a[208:209], v98 offset:8192
    ds_read_b64_tr_b16 a[210:211], v98 offset:8704
    v_mfma_f32_32x32x16_bf16 v[176:191], a[220:223], a[124:127], v[176:191]
    ds_read_b64_tr_b16 a[212:213], v98 offset:10240
    ds_read_b64_tr_b16 a[214:215], v98 offset:10752
    s_barrier
    s_waitcnt lgkmcnt(8)
    v_mfma_f32_32x32x16_bf16 v[128:143], a[192:195], a[64:67], 0
    ds_read_b64_tr_b16 a[216:217], v98 offset:12288
    ds_read_b64_tr_b16 a[218:219], v98 offset:12800
    s_add_u32 m0, s54, 0
    s_nop 0
    v_mfma_f32_32x32x16_bf16 v[128:143], a[196:199], a[68:71], v[128:143]
    ds_read_b64_tr_b16 a[220:221], v98 offset:14336
    ds_read_b64_tr_b16 a[222:223], v98 offset:14848
    s_add_u32 s80, s99, 131072
    s_waitcnt lgkmcnt(8)
    s_nop 0
    v_mfma_f32_32x32x16_bf16 v[128:143], a[200:203], a[72:75], v[128:143]
    ds_read_b64_tr_b16 a[192:193], v98 offset:16384
    ds_read_b64_tr_b16 a[194:195], v98 offset:16896
    v_cvt_pk_bf16_f32 v232, v176, v177
    v_cvt_pk_bf16_f32 v233, v178, v179
    s_mov_b32 s82, 0
    s_nop 0
    buffer_load_dwordx4 v2, s[28:31], s80 offen lds
    v_mfma_f32_32x32x16_bf16 v[128:143], a[204:207], a[76:79], v[128:143]
    ds_read_b64_tr_b16 a[196:197], v98 offset:18432
    ds_read_b64_tr_b16 a[198:199], v98 offset:18944
    v_cvt_pk_bf16_f32 v234, v180, v181
    v_cvt_pk_bf16_f32 v235, v182, v183
    s_add_u32 m0, s54, 4096
    s_waitcnt lgkmcnt(8)
    s_nop 0
    v_mfma_f32_32x32x16_bf16 v[128:143], a[208:211], a[80:83], v[128:143]
    ds_read_b64_tr_b16 a[200:201], v98 offset:20480
    ds_read_b64_tr_b16 a[202:203], v98 offset:20992
    v_cvt_pk_bf16_f32 v236, v184, v185
    v_cvt_pk_bf16_f32 v237, v186, v187
    buffer_store_dwordx4 v[208:211], v4, s[36:39], s82 offen offset:0 sc1
    s_add_u32 s80, s99, 262144
    v_mfma_f32_32x32x16_bf16 v[128:143], a[212:215], a[84:87], v[128:143]
    ds_read_b64_tr_b16 a[204:205], v98 offset:22528
    ds_read_b64_tr_b16 a[206:207], v98 offset:23040
    v_cvt_pk_bf16_f32 v238, v188, v189
    v_cvt_pk_bf16_f32 v239, v190, v191
    buffer_load_dwordx4 v2, s[28:31], s80 offen lds
    s_waitcnt lgkmcnt(8)
    s_nop 0
    v_mfma_f32_32x32x16_bf16 v[128:143], a[216:219], a[88:91], v[128:143]
    ds_read_b64_tr_b16 a[208:209], v98 offset:24576
    ds_read_b64_tr_b16 a[210:211], v98 offset:25088
    s_add_u32 m0, s54, 8192
    v_mfma_f32_32x32x16_bf16 v[128:143], a[220:223], a[92:95], v[128:143]
    ds_read_b64_tr_b16 a[212:213], v98 offset:26624
    ds_read_b64_tr_b16 a[214:215], v98 offset:27136
    buffer_store_dwordx4 v[212:215], v4, s[36:39], s82 offen offset:512 sc1
    s_add_u32 s80, s99, 393216
    s_waitcnt lgkmcnt(8)
    s_nop 0
    v_mfma_f32_32x32x16_bf16 v[128:143], a[192:195], a[96:99], v[128:143]
    ds_read_b64_tr_b16 a[216:217], v98 offset:28672
    ds_read_b64_tr_b16 a[218:219], v98 offset:29184
    buffer_load_dwordx4 v2, s[28:31], s80 offen lds
    v_mfma_f32_32x32x16_bf16 v[128:143], a[196:199], a[100:103], v[128:143]
    ds_read_b64_tr_b16 a[220:221], v98 offset:30720
    ds_read_b64_tr_b16 a[222:223], v98 offset:31232
    s_mov_b32 s82, 2048
    s_add_u32 m0, s54, 12288
    s_waitcnt lgkmcnt(8)
    s_nop 0
    v_mfma_f32_32x32x16_bf16 v[128:143], a[200:203], a[104:107], v[128:143]
    ds_read_b64_tr_b16 a[192:193], v99 offset:0
    ds_read_b64_tr_b16 a[194:195], v99 offset:512
    s_add_u32 s80, s99, 524288
    v_mfma_f32_32x32x16_bf16 v[128:143], a[204:207], a[108:111], v[128:143]
    ds_read_b64_tr_b16 a[196:197], v99 offset:2048
    ds_read_b64_tr_b16 a[198:199], v99 offset:2560
    buffer_load_dwordx4 v2, s[28:31], s80 offen lds
    s_waitcnt lgkmcnt(8)
    s_nop 0
    v_mfma_f32_32x32x16_bf16 v[128:143], a[208:211], a[112:115], v[128:143]
    ds_read_b64_tr_b16 a[200:201], v99 offset:4096
    ds_read_b64_tr_b16 a[202:203], v99 offset:4608
    buffer_store_dwordx4 v[216:219], v4, s[36:39], s82 offen offset:0 sc1
    s_add_u32 m0, s54, 16384
    v_mfma_f32_32x32x16_bf16 v[128:143], a[212:215], a[116:119], v[128:143]
    ds_read_b64_tr_b16 a[204:205], v99 offset:6144
    ds_read_b64_tr_b16 a[206:207], v99 offset:6656
    s_add_u32 s80, s99, 655360
    s_waitcnt lgkmcnt(8)
    s_nop 0
    v_mfma_f32_32x32x16_bf16 v[128:143], a[216:219], a[120:123], v[128:143]
    ds_read_b64_tr_b16 a[208:209], v99 offset:8192
    ds_read_b64_tr_b16 a[210:211], v99 offset:8704
    buffer_store_dwordx4 v[220:223], v4, s[36:39], s82 offen offset:512 sc1
    buffer_load_dwordx4 v2, s[28:31], s80 offen lds
    v_mfma_f32_32x32x16_bf16 v[128:143], a[220:223], a[124:127], v[128:143]
    ds_read_b64_tr_b16 a[212:213], v99 offset:10240
    ds_read_b64_tr_b16 a[214:215], v99 offset:10752
    s_add_u32 m0, s54, 20480
    s_waitcnt lgkmcnt(8)
    s_nop 0
    v_mfma_f32_32x32x16_bf16 v[144:159], a[192:195], a[64:67], 0
    ds_read_b64_tr_b16 a[216:217], v99 offset:12288
    ds_read_b64_tr_b16 a[218:219], v99 offset:12800
    s_add_u32 s80, s99, 786432
    v_mfma_f32_32x32x16_bf16 v[144:159], a[196:199], a[68:71], v[144:159]
    ds_read_b64_tr_b16 a[220:221], v99 offset:14336
    ds_read_b64_tr_b16 a[222:223], v99 offset:14848
    buffer_load_dwordx4 v2, s[28:31], s80 offen lds
    s_waitcnt lgkmcnt(8)
    s_nop 0
    v_mfma_f32_32x32x16_bf16 v[144:159], a[200:203], a[72:75], v[144:159]
    ds_read_b64_tr_b16 a[192:193], v99 offset:16384
    ds_read_b64_tr_b16 a[194:195], v99 offset:16896
    v_cvt_pk_bf16_f32 v208, v128, v129
    v_cvt_pk_bf16_f32 v209, v130, v131
    s_mov_b32 s82, 4096
    v_mfma_f32_32x32x16_bf16 v[144:159], a[204:207], a[76:79], v[144:159]
    ds_read_b64_tr_b16 a[196:197], v99 offset:18432
    ds_read_b64_tr_b16 a[198:199], v99 offset:18944
    v_cvt_pk_bf16_f32 v210, v132, v133
    v_cvt_pk_bf16_f32 v211, v134, v135
    s_add_u32 m0, s54, 24576
    s_waitcnt lgkmcnt(8)
    s_nop 0
    v_mfma_f32_32x32x16_bf16 v[144:159], a[208:211], a[80:83], v[144:159]
    ds_read_b64_tr_b16 a[200:201], v99 offset:20480
    ds_read_b64_tr_b16 a[202:203], v99 offset:20992
    v_cvt_pk_bf16_f32 v212, v136, v137
    v_cvt_pk_bf16_f32 v213, v138, v139
    buffer_store_dwordx4 v[224:227], v4, s[36:39], s82 offen offset:0 sc1
    s_add_u32 s80, s99, 32768
    v_mfma_f32_32x32x16_bf16 v[144:159], a[212:215], a[84:87], v[144:159]
    ds_read_b64_tr_b16 a[204:205], v99 offset:22528
    ds_read_b64_tr_b16 a[206:207], v99 offset:23040
    v_cvt_pk_bf16_f32 v214, v140, v141
    v_cvt_pk_bf16_f32 v215, v142, v143
    buffer_load_dwordx4 v2, s[28:31], s80 offen lds
    s_waitcnt lgkmcnt(8)
    s_nop 0
    v_mfma_f32_32x32x16_bf16 v[144:159], a[216:219], a[88:91], v[144:159]
    ds_read_b64_tr_b16 a[208:209], v99 offset:24576
    ds_read_b64_tr_b16 a[210:211], v99 offset:25088
    s_add_u32 m0, s54, 28672
    v_mfma_f32_32x32x16_bf16 v[144:159], a[220:223], a[92:95], v[144:159]
    ds_read_b64_tr_b16 a[212:213], v99 offset:26624
    ds_read_b64_tr_b16 a[214:215], v99 offset:27136
    buffer_store_dwordx4 v[228:231], v4, s[36:39], s82 offen offset:512 sc1
    s_add_u32 s80, s99, 163840
    s_waitcnt lgkmcnt(8)
    s_nop 0
    v_mfma_f32_32x32x16_bf16 v[144:159], a[192:195], a[96:99], v[144:159]
    ds_read_b64_tr_b16 a[216:217], v99 offset:28672
    ds_read_b64_tr_b16 a[218:219], v99 offset:29184
    buffer_load_dwordx4 v2, s[28:31], s80 offen lds
    v_mfma_f32_32x32x16_bf16 v[144:159], a[196:199], a[100:103], v[144:159]
    ds_read_b64_tr_b16 a[220:221], v99 offset:30720
    ds_read_b64_tr_b16 a[222:223], v99 offset:31232
    s_mov_b32 s82, 6144
    s_add_u32 m0, s54, 32768
    s_waitcnt lgkmcnt(8)
    s_nop 0
    v_mfma_f32_32x32x16_bf16 v[144:159], a[200:203], a[104:107], v[144:159]
    ds_read_b64_tr_b16 a[192:193], v98 offset:32768
    ds_read_b64_tr_b16 a[194:195], v98 offset:33280
    s_add_u32 s80, s99, 294912
    v_mfma_f32_32x32x16_bf16 v[144:159], a[204:207], a[108:111], v[144:159]
    ds_read_b64_tr_b16 a[196:197], v98 offset:34816
    ds_read_b64_tr_b16 a[198:199], v98 offset:35328
    buffer_load_dwordx4 v2, s[28:31], s80 offen lds
    s_waitcnt lgkmcnt(8)
    s_nop 0
    v_mfma_f32_32x32x16_bf16 v[144:159], a[208:211], a[112:115], v[144:159]
    ds_read_b64_tr_b16 a[200:201], v98 offset:36864
    ds_read_b64_tr_b16 a[202:203], v98 offset:37376
    buffer_store_dwordx4 v[232:235], v4, s[36:39], s82 offen offset:0 sc1
    s_add_u32 m0, s54, 36864
    v_mfma_f32_32x32x16_bf16 v[144:159], a[212:215], a[116:119], v[144:159]
    ds_read_b64_tr_b16 a[204:205], v98 offset:38912
    ds_read_b64_tr_b16 a[206:207], v98 offset:39424
    s_add_u32 s80, s99, 425984
    s_waitcnt lgkmcnt(8)
    s_nop 0
    v_mfma_f32_32x32x16_bf16 v[144:159], a[216:219], a[120:123], v[144:159]
    ds_read_b64_tr_b16 a[208:209], v98 offset:40960
    ds_read_b64_tr_b16 a[210:211], v98 offset:41472
    buffer_store_dwordx4 v[236:239], v4, s[36:39], s82 offen offset:512 sc1
    buffer_load_dwordx4 v2, s[28:31], s80 offen lds
    v_mfma_f32_32x32x16_bf16 v[144:159], a[220:223], a[124:127], v[144:159]
    ds_read_b64_tr_b16 a[212:213], v98 offset:43008
    ds_read_b64_tr_b16 a[214:215], v98 offset:43520
    s_add_u32 m0, s54, 40960
    s_waitcnt lgkmcnt(8)
    s_nop 0
    v_mfma_f32_32x32x16_bf16 v[160:175], a[192:195], a[64:67], 0
    ds_read_b64_tr_b16 a[216:217], v98 offset:45056
    ds_read_b64_tr_b16 a[218:219], v98 offset:45568
    s_add_u32 s80, s99, 688128
    v_mfma_f32_32x32x16_bf16 v[160:175], a[196:199], a[68:71], v[160:175]
    ds_read_b64_tr_b16 a[220:221], v98 offset:47104
    ds_read_b64_tr_b16 a[222:223], v98 offset:47616
    buffer_load_dwordx4 v2, s[28:31], s80 offen lds
    s_waitcnt lgkmcnt(8)
    s_nop 0
    v_mfma_f32_32x32x16_bf16 v[160:175], a[200:203], a[72:75], v[160:175]
    ds_read_b64_tr_b16 a[192:193], v98 offset:49152
    ds_read_b64_tr_b16 a[194:195], v98 offset:49664
    v_cvt_pk_bf16_f32 v216, v144, v145
    v_cvt_pk_bf16_f32 v217, v146, v147
    s_mov_b32 s82, 8192
    v_mfma_f32_32x32x16_bf16 v[160:175], a[204:207], a[76:79], v[160:175]
    ds_read_b64_tr_b16 a[196:197], v98 offset:51200
    ds_read_b64_tr_b16 a[198:199], v98 offset:51712
    v_cvt_pk_bf16_f32 v218, v148, v149
    v_cvt_pk_bf16_f32 v219, v150, v151
    s_add_u32 m0, s54, 45056
    s_waitcnt lgkmcnt(8)
    s_nop 0
    v_mfma_f32_32x32x16_bf16 v[160:175], a[208:211], a[80:83], v[160:175]
    ds_read_b64_tr_b16 a[200:201], v98 offset:53248
    ds_read_b64_tr_b16 a[202:203], v98 offset:53760
    v_cvt_pk_bf16_f32 v220, v152, v153
    v_cvt_pk_bf16_f32 v221, v154, v155
    buffer_store_dwordx4 v[208:211], v4, s[36:39], s82 offen offset:0 sc1
    s_add_u32 s80, s99, 819200
    v_mfma_f32_32x32x16_bf16 v[160:175], a[212:215], a[84:87], v[160:175]
    ds_read_b64_tr_b16 a[204:205], v98 offset:55296
    ds_read_b64_tr_b16 a[206:207], v98 offset:55808
    v_cvt_pk_bf16_f32 v222, v156, v157
    v_cvt_pk_bf16_f32 v223, v158, v159
    buffer_load_dwordx4 v2, s[28:31], s80 offen lds
    s_waitcnt lgkmcnt(8)
    s_nop 0
    v_mfma_f32_32x32x16_bf16 v[160:175], a[216:219], a[88:91], v[160:175]
    ds_read_b64_tr_b16 a[208:209], v98 offset:57344
    ds_read_b64_tr_b16 a[210:211], v98 offset:57856
    s_add_u32 m0, s54, 49152
    v_mfma_f32_32x32x16_bf16 v[160:175], a[220:223], a[92:95], v[160:175]
    ds_read_b64_tr_b16 a[212:213], v98 offset:59392
    ds_read_b64_tr_b16 a[214:215], v98 offset:59904
    buffer_store_dwordx4 v[212:215], v4, s[36:39], s82 offen offset:512 sc1
    s_mov_b32 s80, 65536
    s_waitcnt lgkmcnt(8)
    s_nop 0
    v_mfma_f32_32x32x16_bf16 v[160:175], a[192:195], a[96:99], v[160:175]
    ds_read_b64_tr_b16 a[216:217], v98 offset:61440
    ds_read_b64_tr_b16 a[218:219], v98 offset:61952
    buffer_load_dwordx4 v2, s[28:31], s80 offen lds
    v_mfma_f32_32x32x16_bf16 v[160:175], a[196:199], a[100:103], v[160:175]
    ds_read_b64_tr_b16 a[220:221], v98 offset:63488
    ds_read_b64_tr_b16 a[222:223], v98 offset:64000
    s_add_u32 m0, s54, 53248
    s_waitcnt lgkmcnt(8)
    s_nop 0
    v_mfma_f32_32x32x16_bf16 v[160:175], a[200:203], a[104:107], v[160:175]
    ds_read_b64_tr_b16 a[192:193], v99 offset:32768
    ds_read_b64_tr_b16 a[194:195], v99 offset:33280
    s_mov_b32 s80, 196608
    v_mfma_f32_32x32x16_bf16 v[160:175], a[204:207], a[108:111], v[160:175]
    ds_read_b64_tr_b16 a[196:197], v99 offset:34816
    ds_read_b64_tr_b16 a[198:199], v99 offset:35328
    buffer_load_dwordx4 v2, s[28:31], s80 offen lds
    s_waitcnt lgkmcnt(8)
    s_nop 0
    v_mfma_f32_32x32x16_bf16 v[160:175], a[208:211], a[112:115], v[160:175]
    ds_read_b64_tr_b16 a[200:201], v99 offset:36864
    ds_read_b64_tr_b16 a[202:203], v99 offset:37376
    s_add_u32 m0, s54, 57344
    v_mfma_f32_32x32x16_bf16 v[160:175], a[212:215], a[116:119], v[160:175]
    ds_read_b64_tr_b16 a[204:205], v99 offset:38912
    ds_read_b64_tr_b16 a[206:207], v99 offset:39424
    s_mov_b32 s80, 327680
    s_waitcnt lgkmcnt(8)
    s_nop 0
    v_mfma_f32_32x32x16_bf16 v[160:175], a[216:219], a[120:123], v[160:175]
    ds_read_b64_tr_b16 a[208:209], v99 offset:40960
    ds_read_b64_tr_b16 a[210:211], v99 offset:41472
    buffer_load_dwordx4 v2, s[28:31], s80 offen lds
    v_mfma_f32_32x32x16_bf16 v[160:175], a[220:223], a[124:127], v[160:175]
    ds_read_b64_tr_b16 a[212:213], v99 offset:43008
    ds_read_b64_tr_b16 a[214:215], v99 offset:43520
    s_add_u32 m0, s54, 61440
    s_waitcnt lgkmcnt(8)
    s_nop 0
    v_mfma_f32_32x32x16_bf16 v[176:191], a[192:195], a[64:67], 0
    ds_read_b64_tr_b16 a[216:217], v99 offset:45056
    ds_read_b64_tr_b16 a[218:219], v99 offset:45568
    s_mov_b32 s80, 458752
    v_mfma_f32_32x32x16_bf16 v[176:191], a[196:199], a[68:71], v[176:191]
    ds_read_b64_tr_b16 a[220:221], v99 offset:47104
    ds_read_b64_tr_b16 a[222:223], v99 offset:47616
    buffer_load_dwordx4 v2, s[28:31], s80 offen lds
    s_waitcnt lgkmcnt(8)
    s_nop 0
    v_mfma_f32_32x32x16_bf16 v[176:191], a[200:203], a[72:75], v[176:191]
    ds_read_b64_tr_b16 a[192:193], v99 offset:49152
    ds_read_b64_tr_b16 a[194:195], v99 offset:49664
    v_cvt_pk_bf16_f32 v224, v160, v161
    v_cvt_pk_bf16_f32 v225, v162, v163
    s_mov_b32 s82, 10240
    v_mfma_f32_32x32x16_bf16 v[176:191], a[204:207], a[76:79], v[176:191]
    ds_read_b64_tr_b16 a[196:197], v99 offset:51200
    ds_read_b64_tr_b16 a[198:199], v99 offset:51712
    v_cvt_pk_bf16_f32 v226, v164, v165
    v_cvt_pk_bf16_f32 v227, v166, v167
    s_waitcnt lgkmcnt(8)
    s_nop 0
    v_mfma_f32_32x32x16_bf16 v[176:191], a[208:211], a[80:83], v[176:191]
    ds_read_b64_tr_b16 a[200:201], v99 offset:53248
    ds_read_b64_tr_b16 a[202:203], v99 offset:53760
    v_cvt_pk_bf16_f32 v228, v168, v169
    v_cvt_pk_bf16_f32 v229, v170, v171
    buffer_store_dwordx4 v[216:219], v4, s[36:39], s82 offen offset:0 sc1
    v_mfma_f32_32x32x16_bf16 v[176:191], a[212:215], a[84:87], v[176:191]
    ds_read_b64_tr_b16 a[204:205], v99 offset:55296
    ds_read_b64_tr_b16 a[206:207], v99 offset:55808
    v_cvt_pk_bf16_f32 v230, v172, v173
    v_cvt_pk_bf16_f32 v231, v174, v175
    s_waitcnt lgkmcnt(8)
    s_nop 0
    v_mfma_f32_32x32x16_bf16 v[176:191], a[216:219], a[88:91], v[176:191]
    ds_read_b64_tr_b16 a[208:209], v99 offset:57344
    ds_read_b64_tr_b16 a[210:211], v99 offset:57856
    v_mfma_f32_32x32x16_bf16 v[176:191], a[220:223], a[92:95], v[176:191]
    ds_read_b64_tr_b16 a[212:213], v99 offset:59392
    ds_read_b64_tr_b16 a[214:215], v99 offset:59904
    buffer_store_dwordx4 v[220:223], v4, s[36:39], s82 offen offset:512 sc1
    s_waitcnt lgkmcnt(8)
    s_nop 0
    v_mfma_f32_32x32x16_bf16 v[176:191], a[192:195], a[96:99], v[176:191]
    ds_read_b64_tr_b16 a[216:217], v99 offset:61440
    ds_read_b64_tr_b16 a[218:219], v99 offset:61952
    v_mfma_f32_32x32x16_bf16 v[176:191], a[196:199], a[100:103], v[176:191]
    ds_read_b64_tr_b16 a[220:221], v99 offset:63488
    ds_read_b64_tr_b16 a[222:223], v99 offset:64000
    s_waitcnt lgkmcnt(8)
    v_mfma_f32_32x32x16_bf16 v[176:191], a[200:203], a[104:107], v[176:191]
    v_mfma_f32_32x32x16_bf16 v[176:191], a[204:207], a[108:111], v[176:191]
    s_waitcnt lgkmcnt(4)
    v_mfma_f32_32x32x16_bf16 v[176:191], a[208:211], a[112:115], v[176:191]
    v_mfma_f32_32x32x16_bf16 v[176:191], a[212:215], a[116:119], v[176:191]
    s_waitcnt lgkmcnt(0)
    v_mfma_f32_32x32x16_bf16 v[176:191], a[216:219], a[120:123], v[176:191]
    v_mfma_f32_32x32x16_bf16 v[176:191], a[220:223], a[124:127], v[176:191]
    s_nop 11
    v_cvt_pk_bf16_f32 v232, v176, v177
    v_cvt_pk_bf16_f32 v233, v178, v179
    v_cvt_pk_bf16_f32 v234, v180, v181
    v_cvt_pk_bf16_f32 v235, v182, v183
    v_cvt_pk_bf16_f32 v236, v184, v185
    v_cvt_pk_bf16_f32 v237, v186, v187
    v_cvt_pk_bf16_f32 v238, v188, v189
    v_cvt_pk_bf16_f32 v239, v190, v191
    s_barrier
    s_cmp_lg_u32 s48, 3
    s_cbranch_scc1 Lpi40
    s_load_dword s69, s[36:37], s64 offset:128 glc
Lpi40:
    s_add_u32 m0, s54, 81920
    s_mov_b32 s80, 1114112
    buffer_load_dwordx4 v2, s[28:31], s80 offen lds
    s_add_u32 m0, s54, 86016
    s_mov_b32 s80, 1245184
    buffer_load_dwordx4 v2, s[28:31], s80 offen lds
    s_add_u32 m0, s54, 90112
    s_mov_b32 s80, 1376256
    buffer_load_dwordx4 v2, s[28:31], s80 offen lds
    s_add_u32 m0, s54, 94208
    s_mov_b32 s80, 1507328
    buffer_load_dwordx4 v2, s[28:31], s80 offen lds
    s_cmp_lg_u32 s48, 3
    s_cbranch_scc1 Lpolld42
    s_waitcnt lgkmcnt(0)
    s_cmp_lt_u32 s69, 7
    s_cbranch_scc1 Lpoll41
Lpolld42:
    s_add_u32 m0, s54, 98304
    s_mov_b32 s80, 1638400
    buffer_load_dwordx4 v2, s[28:31], s80 offen lds
    s_add_u32 m0, s54, 102400
    s_mov_b32 s80, 1769472
    buffer_load_dwordx4 v2, s[28:31], s80 offen lds
    s_add_u32 m0, s54, 106496
    s_mov_b32 s80, 98304
    buffer_load_dwordx4 v2, s[28:31], s80 offen lds
    s_waitcnt vmcnt(0)
    s_barrier
    ds_read_b64_tr_b16 a[192:193], v92 offset:4096
    ds_read_b64_tr_b16 a[194:195], v92 offset:4608
    ds_read_b64_tr_b16 a[196:197], v93 offset:4096
    ds_read_b64_tr_b16 a[198:199], v93 offset:4608
    ds_read_b64_tr_b16 a[200:201], v92 offset:8192
    ds_read_b64_tr_b16 a[202:203], v92 offset:8704
    ds_read_b64_tr_b16 a[204:205], v93 offset:8192
    ds_read_b64_tr_b16 a[206:207], v93 offset:8704
    ds_read_b64_tr_b16 a[208:209], v92 offset:12288
    ds_read_b64_tr_b16 a[210:211], v92 offset:12800
    ds_read_b64_tr_b16 a[212:213], v93 offset:12288
    ds_read_b64_tr_b16 a[214:215], v93 offset:12800
    s_mov_b32 s82, 0
    s_mov_b32 s98, 0
    buffer_load_dwordx4 a[32:35], v22, s[36:39], s98 offen offset:0 sc1
    s_mov_b32 s98, 4096
    buffer_load_dwordx4 a[36:39], v22, s[36:39], s98 offen offset:0 sc1
    s_mov_b32 s98, 8192
    buffer_load_dwordx4 a[40:43], v22, s[36:39], s98 offen offset:0 sc1
    s_mov_b32 s98, 12288
    buffer_load_dwordx4 a[44:47], v22, s[36:39], s98 offen offset:0 sc1
    s_mov_b32 s98, 16384
    buffer_load_dwordx4 a[48:51], v22, s[36:39], s98 offen offset:0 sc1
    s_mov_b32 s98, 20480
    buffer_load_dwordx4 a[52:55], v22, s[36:39], s98 offen offset:0 sc1
    s_mov_b32 s98, 24576
    buffer_load_dwordx4 a[56:59], v22, s[36:39], s98 offen offset:0 sc1
    s_mov_b32 s82, 12288
    buffer_store_dwordx4 v[224:227], v4, s[36:39], s82 offen offset:0 sc1
    buffer_store_dwordx4 v[228:231], v4, s[36:39], s82 offen offset:512 sc1
    s_mov_b32 s82, 14336
    buffer_store_dwordx4 v[232:235], v4, s[36:39], s82 offen offset:0 sc1
    buffer_store_dwordx4 v[236:239], v4, s[36:39], s82 offen offset:512 sc1
    s_mov_b32 s82, 0
    s_waitcnt lgkmcnt(0)
    s_branch Ljoin1
Lpoll45:
    s_mov_b32 s55, 200000
Lpoll45x:
    s_sleep 2
    s_sub_u32 s55, s55, 1
    s_cbranch_scc1 Lpolld46
    s_load_dword s69, s[36:37], s64 offset:4 glc
    s_waitcnt lgkmcnt(0)
    s_cmp_lt_u32 s69, 7
    s_cbranch_scc1 Lpoll45x
    s_branch Lpolld46
Lpoll49:
    s_mov_b32 s55, 200000
Lpoll49x:
    s_sleep 2
    s_sub_u32 s55, s55, 1
    s_cbranch_scc1 Lpolld50
    s_load_dword s69, s[36:37], s64 offset:256 glc
    s_load_dword s70, s[36:37], s65 offset:256 glc
    s_waitcnt lgkmcnt(0)
    s_min_u32 s69, s69, s70
    s_cmp_lt_u32 s69, 7
    s_cbranch_scc1 Lpoll49x
    s_branch Lpolld50
Lpoll53:
    s_mov_b32 s55, 200000
Lpoll53x:
    s_sleep 2
    s_sub_u32 s55, s55, 1
    s_cbranch_scc1 Lpolld54
    s_load_dword s69, s[36:37], s64 offset:384 glc
    s_load_dword s70, s[36:37], s65 offset:384 glc
    s_waitcnt lgkmcnt(0)
    s_min_u32 s69, s69, s70
    s_cmp_lt_u32 s69, 8
    s_cbranch_scc1 Lpoll53x
    s_branch Lpolld54
Lpoll56:
    s_mov_b32 s55, 200000
Lpoll56x:
    s_sleep 2
    s_sub_u32 s55, s55, 1
    s_cbranch_scc1 Lpolld57
    s_load_dword s69, s[36:37], s57 offset:144 glc
    s_waitcnt lgkmcnt(0)
    s_cmp_lt_u32 s69, 1
    s_cbranch_scc1 Lpoll56x
    s_branch Lpolld57
Lend:
    s_endpgm
.section .rodata,"a"
.p2align 6
.amdhsa_kernel parallel_sum__sliding_local_dilated__mixer_s_mlp__prompt_kernel
  .amdhsa_next_free_vgpr 512
  .amdhsa_next_free_sgpr 102
  .amdhsa_accum_offset 256
  .amdhsa_group_segment_fixed_size 0
  .amdhsa_kernarg_size 88
  .amdhsa_user_sgpr_count 2
  .amdhsa_user_sgpr_kernarg_segment_ptr 1
  .amdhsa_system_sgpr_workgroup_id_x 1
  .amdhsa_float_denorm_mode_32 3
  .amdhsa_float_denorm_mode_16_64 3
.end_amdhsa_kernel
```
